```python
import torch

def _softmax(x, axis=-1):
    return torch.softmax(x, dim=axis)

def _gelu(x):
    return torch.nn.functional.gelu(x, approximate='tanh')

def _silu(x):
    return torch.nn.functional.silu(x)

def _sigmoid(x):
    return torch.sigmoid(x)

def _layernorm(x, axis=-1, eps=1e-05):
    m = x.mean(dim=axis, keepdim=True)
    v = x.var(dim=axis, keepdim=True, unbiased=False)
    return (x - m) / torch.sqrt(v + eps)

def _scatter_add(tgt, idx, src, axis=0):
    return tgt.clone().index_add_(axis, idx, src)

def _segment_sum(src, seg, n):
    out = torch.zeros((n,) + src.shape[1:], dtype=src.dtype)
    return out.index_add_(0, seg, src)

def _pad(x, pw):
    flat = tuple((v for pair in reversed(pw) for v in pair))
    return torch.nn.functional.pad(x, flat)
kernel_name = 'adaLN_cond__ssm_conv_h3__dense_activation_squared_relu__prompt'

def setup_inputs():

    _w = lambda a: (lambda t: t.to(torch.bfloat16) if t.is_floating_point() else t)(torch.as_tensor(a))

    def _A_setup():
        B, S, D = (1, 2048, 512)
        ks = 4
        return {'q': _w((lambda *s: torch.randn(*s, dtype=torch.bfloat16) * 0.05)(B, S, D)), 'k': _w((lambda *s: torch.randn(*s, dtype=torch.bfloat16) * 0.8)(B, S, D)), 'v': _w((lambda *s: torch.randn(*s, dtype=torch.bfloat16) * 0.8)(B, S, D)), 'shift_k': _w((lambda *s: torch.randn(*s, dtype=torch.bfloat16) * 0.8)(D, ks) * 0.5), 'ssm_k': _w((lambda *s: torch.randn(*s, dtype=torch.bfloat16) * 0.8)(D, S) * (1.0 / S ** 0.5)), 'ssm_D': _w((lambda *s: torch.randn(*s, dtype=torch.bfloat16) * 0.8)(D))}
    _A_in = _A_setup()

    def _B_setup():
        B, S, D, F = (1, 2048, 512, 1376)
        return {'x': _w((lambda *s: torch.randn(*s, dtype=torch.bfloat16) * 0.05)(B, S, D)), 'w1': _w((lambda *s: torch.randn(*s, dtype=torch.bfloat16) * 0.05)(D, F)), 'b1': _w((lambda *s: torch.randn(*s, dtype=torch.bfloat16) * 0.4)(F)), 'w2': _w((lambda *s: torch.randn(*s, dtype=torch.bfloat16) * 0.05)(F, D)), 'b2': _w((lambda *s: torch.randn(*s, dtype=torch.bfloat16) * 3.2)(D))}
    _B_in = _B_setup()
    return {'A_q': _A_in['q'], 'A_k': _A_in['k'], 'A_v': _A_in['v'], 'A_shift_k': _A_in['shift_k'], 'A_ssm_k': _A_in['ssm_k'], 'A_ssm_D': _A_in['ssm_D'], 'B_x': _B_in['x'], 'B_w1': _B_in['w1'], 'B_b1': _B_in['b1'], 'B_w2': _B_in['w2'], 'B_b2': _B_in['b2'], 'c': _w((lambda *s: torch.randn(*s, dtype=torch.bfloat16) * 0.1)(1, 512) * 8.0), 'w_mod': _w((lambda *s: torch.randn(*s, dtype=torch.bfloat16) * 0.1)(512, 6 * 512) * 512 ** (-0.5) * 8.0)}

def reference(A_q, A_k, A_v, A_shift_k, A_ssm_k, A_ssm_D, B_x, B_w1, B_b1, B_w2, B_b2, c, w_mod):

    def _A_ref(q, k, v, shift_k, ssm_k, ssm_D):
        B, S, D = q.shape
        ks = shift_k.shape[-1]
        k_pad = _pad(k, ((0, 0), (ks - 1, 0), (0, 0)))
        k_shift = torch.zeros_like(k)
        for t in range(ks):
            k_shift = k_shift + k_pad[:, t:t + S, :] * shift_k[:, ks - 1 - t][None, None, :]
        kv = k_shift * v
        L = 2 * S
        kv_pad = _pad(kv, ((0, 0), (0, S), (0, 0)))
        kf_pad = _pad(ssm_k, ((0, 0), (0, S)))
        kv_f = (lambda x, axes=(-2, -1): torch.fft.rfft2(x.float(), dim=axes))(kv_pad[:, None, :, :], axes=(1, 2))
        kf_f = (lambda x, axes=(-2, -1): torch.fft.rfft2(x.float(), dim=axes))(kf_pad[:, None, :], axes=(1, 2))
        kf_f = (lambda x, *d: x.permute(*d))(kf_f, 1, 2, 0)
        y_f = kv_f * kf_f[None, :, :, :]
        y = (lambda x, s, axes=(-2, -1): torch.fft.irfft2(x, s=s, dim=axes).to(torch.bfloat16))(y_f, (1, L), axes=(1, 2))[:, 0, :S, :]
        y = y + kv * ssm_D[None, None, :]
        return q * y

    def _B_ref(x, w1, b1, w2, b2):
        h = torch.einsum('bsd,df->bsf', x, w1) + b1
        zero = torch.zeros_like(h)
        r = torch.where(h > zero, h, zero)
        h = r * r
        out = torch.einsum('bsf,fd->bsd', h, w2) + b2
        return out
    x = A_q
    mod = (_silu(c) @ w_mod).reshape(c.shape[0], 6, 1, -1)
    sa, ca, ga, sb, cb, gb = (mod[:, 0].clone(), mod[:, 1].clone(), mod[:, 2].clone(), mod[:, 3].clone(), mod[:, 4].clone(), mod[:, 5].clone())
    h = _layernorm(x, axis=-1) * (1 + ca) + sa
    x = x + ga * _A_ref(h, A_k, A_v, A_shift_k, A_ssm_k, A_ssm_D)
    h = _layernorm(x, axis=-1) * (1 + cb) + sb
    x = x + gb * _B_ref(h, B_w1, B_b1, B_w2, B_b2)
    return x
```

```asm
; @launch grid=(256,1,1) block=(256,1,1) lds=139392
.amdgcn_target "amdgcn-amd-amdhsa--gfx950"
.text
.globl adaLN_cond__ssm_conv_h3__dense_activation_squared_relu__prompt_kernel
.p2align 8
.type adaLN_cond__ssm_conv_h3__dense_activation_squared_relu__prompt_kernel,@function
adaLN_cond__ssm_conv_h3__dense_activation_squared_relu__prompt_kernel:
    s_cmp_ge_u32 s2, 256
    s_cbranch_scc1 k_done
    s_load_dwordx16 s[64:79], s[0:1], 0
    s_load_dwordx16 s[80:95], s[0:1], 64
    s_getpc_b64 s[48:49]
k_pc:
    v_lshrrev_b32 v1, 6, v0
    v_and_b32 v2, 63, v0
    v_readfirstlane_b32 s52, v1
    s_and_b32 s53, s2, 7
    s_lshr_b32 s54, s2, 3
    v_and_b32 v3, 15, v2
    v_lshrrev_b32 v4, 4, v2
    s_lshr_b32 s56, s54, 3
    s_lshl_b32 s56, s56, 3
    s_add_u32 s96, s53, s56
    s_and_b32 s97, s54, 7
    s_lshl_b32 s98, s53, 6
    s_lshl_b32 s56, s54, 1
    s_add_u32 s98, s98, s56
    s_mov_b32 s99, 0x3f803f80
    v_lshrrev_b32 v5, 3, v2
    v_lshlrev_b32 v5, 10, v5
    v_and_b32 v6, 7, v2
    v_lshl_add_u32 v5, v6, 4, v5
    s_lshl_b32 s56, s54, 16
    s_lshl_b32 s57, s53, 7
    s_add_u32 s56, s56, s57
    v_add_u32 v7, s56, v5
    v_subrev_u32 v7, 8192, v7
    s_lshl_b32 s57, s52, 14
    s_add_u32 s56, s56, s57
    v_add_u32 v5, s56, v5
    v_and_b32 v12, 31, v0
    v_lshrrev_b32 v13, 5, v0
    v_lshlrev_b32 v8, 4, v12
    s_lshl_b32 s56, s53, 9
    v_add_u32 v8, s56, v8
    s_lshl_b32 s60, s52, 11
    s_movk_i32 s61, 8192
    s_waitcnt lgkmcnt(0)
    s_mov_b32 s8, s66
    s_mov_b32 s9, s67
    s_mov_b32 s10, 0x200000
    s_mov_b32 s11, 0x00020000
    s_mov_b32 s12, s68
    s_mov_b32 s13, s69
    s_mov_b32 s14, 0x200000
    s_mov_b32 s15, 0x00020000
    s_mov_b32 s20, s70
    s_mov_b32 s21, s71
    s_mov_b32 s22, 0x1000
    s_mov_b32 s23, 0x00020000
    s_mov_b32 s16, s64
    s_mov_b32 s17, s65
    s_mov_b32 s18, 0x200000
    s_mov_b32 s19, 0x00020000
    s_cmp_lg_u32 s52, 3
    s_cbranch_scc1 nohalo
    s_mov_b32 m0, 65536
    s_nop 0
    buffer_load_dwordx4 v7, s[8:11], 0 offen lds
nohalo:
    s_add_u32 s56, s60, 66560
    s_mov_b32 m0, s56
    s_nop 0
    buffer_load_dwordx4 v5, s[8:11], 0 offen nt lds
    s_add_u32 s56, s60, 67584
    s_mov_b32 m0, s56
    s_nop 0
    buffer_load_dwordx4 v5, s[8:11], s61 offen nt lds
    s_add_u32 s56, s60, 74752
    s_mov_b32 m0, s56
    s_nop 0
    buffer_load_dwordx4 v5, s[12:15], 0 offen nt lds
    s_add_u32 s56, s60, 75776
    s_mov_b32 m0, s56
    s_nop 0
    buffer_load_dwordx4 v5, s[12:15], s61 offen nt lds
    s_add_u32 s56, s60, 82944
    s_mov_b32 m0, s56
    s_nop 0
    buffer_load_dwordx4 v5, s[16:19], 0 offen nt lds
    s_add_u32 s56, s60, 83968
    s_mov_b32 m0, s56
    s_nop 0
    buffer_load_dwordx4 v5, s[16:19], s61 offen nt lds
    buffer_load_dwordx4 v[44:47], v8, s[20:23], 0 offen
    s_mul_i32 s56, s54, 43
    s_lshr_b32 s56, s56, 8
    s_mul_i32 s56, s56, 6
    s_sub_u32 s56, s54, s56
    s_lshl_b32 s56, s56, 12
    v_lshl_add_u32 v9, v0, 4, s56
    v_min_u32 v9, k_end-k_pc-16, v9
    global_load_dwordx4 a[0:3], v9, s[48:49]
    s_mov_b32 s4, s94
    s_mov_b32 s5, s95
    s_mov_b32 s6, 0x1500000
    s_mov_b32 s7, 0x00020000
    s_mov_b32 s24, s72
    s_mov_b32 s25, s73
    s_mov_b32 s26, 0x200000
    s_mov_b32 s27, 0x00020000
    s_mov_b32 s28, s74
    s_mov_b32 s29, s75
    s_mov_b32 s30, 0x400
    s_mov_b32 s31, 0x00020000
    s_mov_b32 s32, s86
    s_mov_b32 s33, s87
    s_mov_b32 s34, 0x400
    s_mov_b32 s35, 0x00020000
    s_mov_b32 s36, s88
    s_mov_b32 s37, s89
    s_mov_b32 s38, 0x300000
    s_mov_b32 s39, 0x00020000
    s_mov_b32 s48, s90
    s_mov_b32 s49, s91
    s_mov_b32 s50, 0x200000
    s_mov_b32 s51, 0x00020000
    v_mov_b32 v142, 19988480
    buffer_load_dword v142, v142, s[4:7], 0 offen sc1
    s_sub_u32 s56, s2, 74
    v_lshlrev_b32 v90, 4, v2
    v_bfe_u32 v9, v2, 2, 2
    v_and_b32 v10, 3, v2
    s_cmp_lt_u32 s56, 96
    s_cbranch_scc0 pk_w2
    s_mov_b32 s40, s78
    s_mov_b32 s41, s79
    s_mov_b32 s42, 0x158000
    s_mov_b32 s43, 0x00020000
    s_and_b32 s57, s56, 15
    s_lshr_b32 s58, s56, 4
    v_lshrrev_b32 v11, 5, v2
    v_bfe_u32 v14, v2, 1, 4
    s_and_b32 s59, s52, 1
    s_lshl_b32 s59, s59, 2
    v_or_b32 v15, s59, v11
    v_xor_b32 v14, v14, v15
    v_xor_b32 v15, 2, v14
    v_mul_u32_u24 v11, 2752, v11
    v_and_b32 v16, 1, v2
    v_lshl_add_u32 v11, v16, 4, v11
    s_mul_i32 s59, s57, 88064
    s_mul_i32 s60, s52, 22016
    s_add_u32 s59, s59, s60
    s_lshl_b32 s60, s58, 9
    s_add_u32 s59, s59, s60
    v_add_u32 v11, s59, v11
    v_lshl_add_u32 v88, v14, 5, v11
    v_lshl_add_u32 v89, v15, 5, v11
    s_movk_i32 s44, 5504
    v_and_b32 v14, 1, v4
    v_lshl_or_b32 v14, v14, 2, v9
    v_lshl_add_u32 v15, v4, 3, v9
    v_lshlrev_b32 v15, 9, v15
    v_lshl_add_u32 v15, v10, 3, v15
    v_add_u32 v15, 107520, v15
    s_lshl_b32 s59, s52, 2
    v_xor_b32 v14, s59, v14
    v_xor_b32 v16, 0, v14
    v_lshl_add_u32 v92, v16, 5, v15
    v_add_u32 v96, 2048, v92
    v_xor_b32 v16, 1, v14
    v_lshl_add_u32 v93, v16, 5, v15
    v_add_u32 v97, 2048, v93
    v_xor_b32 v16, 2, v14
    v_lshl_add_u32 v94, v16, 5, v15
    v_add_u32 v98, 2048, v94
    v_xor_b32 v16, 3, v14
    v_lshl_add_u32 v95, v16, 5, v15
    v_add_u32 v99, 2048, v95
    s_lshl_b32 s58, s58, 2
    s_add_u32 s58, s58, s52
    s_lshl_b32 s59, s58, 16
    s_lshl_b32 s60, s57, 10
    s_add_u32 s59, s59, s60
    s_add_u32 s59, s59, 14680064
    s_cmp_ge_u32 s58, 22
    s_cselect_b32 s59, 1073741824, s59
    v_add_u32 v90, s59, v90
    s_movk_i32 s45, 16384
    s_cmp_eq_u32 s58, 21
    s_cselect_b32 s46, 1073741824, 0
    s_branch pk_go
pk_w2:
    s_mov_b32 s40, s82
    s_mov_b32 s41, s83
    s_mov_b32 s42, 0x158000
    s_mov_b32 s43, 0x00020000
    s_sub_u32 s57, s2, 170
    v_bfe_u32 v14, v2, 2, 2
    v_xor_b32 v14, v14, v4
    v_lshlrev_b32 v11, 10, v4
    v_lshl_add_u32 v11, v14, 6, v11
    v_lshl_add_u32 v11, v10, 4, v11
    s_lshl_b32 s59, s57, 14
    s_lshl_b32 s60, s52, 8
    s_add_u32 s59, s59, s60
    s_cmp_ge_u32 s57, 86
    s_cselect_b32 s59, 1073741824, s59
    v_add_u32 v88, s59, v11
    v_mov_b32 v89, v88
    s_movk_i32 s44, 4096
    v_lshrrev_b32 v14, 1, v4
    v_lshl_add_u32 v14, v14, 3, v9
    v_lshlrev_b32 v14, 8, v14
    v_and_b32 v15, 1, v4
    v_lshl_add_u32 v14, v15, 5, v14
    v_lshl_add_u32 v14, v10, 3, v14
    s_lshl_b32 s59, s52, 12
    s_add_u32 s59, s59, 107520
    v_add_u32 v14, s59, v14
    v_xor_b32 v16, 0, v9
    v_lshl_add_u32 v92, v16, 6, v14
    v_add_u32 v96, 1024, v92
    v_xor_b32 v16, 1, v9
    v_lshl_add_u32 v93, v16, 6, v14
    v_add_u32 v97, 1024, v93
    v_xor_b32 v16, 2, v9
    v_lshl_add_u32 v94, v16, 6, v14
    v_add_u32 v98, 1024, v94
    v_xor_b32 v16, 3, v9
    v_lshl_add_u32 v95, v16, 6, v14
    v_add_u32 v99, 1024, v95
    s_mul_i32 s59, s52, 352256
    s_lshl_b32 s60, s57, 10
    s_add_u32 s59, s59, s60
    s_add_u32 s59, s59, 16777216
    s_cmp_ge_u32 s57, 86
    s_cselect_b32 s59, 1073741824, s59
    v_add_u32 v90, s59, v90
    s_mov_b32 s45, 88064
    s_mov_b32 s46, 0
pk_go:
    s_lshl_b32 s60, s52, 12
    s_mov_b32 s47, 0
    s_mul_i32 s56, s2, 1366
    s_lshr_b32 s56, s56, 16
    s_mul_i32 s57, s56, 48
    s_sub_u32 s57, s2, s57
    s_mul_i32 s3, s56, 12288
    s_lshl_b32 s58, s57, 8
    s_add_u32 s3, s3, s58
    s_add_u32 s3, s3, 18874368
    s_cmp_ge_u32 s2, 192
    s_cselect_b32 s3, 1073741824, s3
    s_mul_i32 s58, s56, 786432
    s_lshl_b32 s59, s57, 7
    s_add_u32 s58, s58, s59
    s_cmp_ge_u32 s2, 192
    s_cselect_b32 s58, 1073741824, s58
    v_and_b32 v22, 7, v0
    v_lshrrev_b32 v23, 3, v0
    v_mul_u32_u24 v24, 24576, v23
    v_lshl_add_u32 v24, v22, 4, v24
    v_add_u32 v24, s58, v24
    v_lshlrev_b32 v23, 3, v23
    s_lshl_b32 s56, s56, 8
    v_add_u32 v23, s56, v23
    buffer_load_dwordx2 v[68:69], v23, s[32:35], 0 offen
    s_mov_b32 s56, 0
    buffer_load_dwordx4 v[72:75], v24, s[36:39], s56 offen nt
    s_mov_b32 s56, 6144
    buffer_load_dwordx4 v[76:79], v24, s[36:39], s56 offen nt
    s_mov_b32 s56, 12288
    buffer_load_dwordx4 v[80:83], v24, s[36:39], s56 offen nt
    s_mov_b32 s56, 18432
    buffer_load_dwordx4 v[84:87], v24, s[36:39], s56 offen nt
    v_lshlrev_b32 v5, 10, v13
    v_lshl_add_u32 v5, v12, 2, v5
    v_add_u32 v6, 67200, v5
    v_add_u32 v5, 66176, v5
    v_subrev_u32 v7, -8576, v5
    v_add_u32 v8, 8192, v7
    v_and_b32 v9, 7, v12
    v_sub_u32 v10, 7, v13
    v_xor_b32 v10, v10, v9
    v_lshlrev_b32 v14, 8, v12
    v_lshl_add_u32 v15, v10, 4, v14
    v_add_u32 v15, 91136, v15
    v_lshlrev_b32 v10, 1, v13
    v_xor_b32 v10, v10, v9
    v_lshl_add_u32 v16, v10, 4, v14
    v_add_u32 v16, 99328, v16
    v_xor_b32 v17, 16, v16
    v_lshrrev_b32 v9, 3, v0
    v_and_b32 v10, 7, v0
    v_bfe_u32 v11, v0, 4, 3
    v_xor_b32 v11, v11, v10
    v_lshlrev_b32 v18, 7, v9
    v_lshl_add_u32 v18, v11, 4, v18
    v_add_u32 v18, 91136, v18
    v_lshlrev_b32 v19, 12, v9
    v_lshl_add_u32 v19, v10, 4, v19
    s_lshl_b32 s56, s53, 18
    s_lshl_b32 s57, s54, 7
    s_sub_u32 s56, s56, s57
    s_add_u32 s56, s56, 3968
    v_add_u32 v19, s56, v19
    v_lshrrev_b32 v9, 4, v0
    v_and_b32 v11, 7, v9
    v_xor_b32 v11, v11, v3
    v_lshlrev_b32 v20, 8, v9
    v_lshl_add_u32 v20, v11, 4, v20
    v_add_u32 v20, 99328, v20
    v_lshlrev_b32 v21, 13, v9
    v_lshl_add_u32 v21, v3, 4, v21
    s_lshl_b32 s56, s53, 18
    s_lshl_b32 s57, s54, 8
    s_add_u32 s56, s56, s57
    s_add_u32 s56, s56, 2097152
    v_add_u32 v21, s56, v21
    s_waitcnt vmcnt(7)
    s_barrier
    ds_read2_b32 v[144:145], v5 offset0:0 offset1:32
    ds_read2_b32 v[146:147], v5 offset0:64 offset1:96
    ds_read2_b32 v[148:149], v5 offset0:128 offset1:160
    ds_read2_b32 v[150:151], v5 offset0:192 offset1:224
    ds_read2_b32 v[152:153], v6 offset0:0 offset1:32
    ds_read_b32 v154, v6 offset:256
    ds_read2_b32 v[156:157], v7 offset0:0 offset1:32
    ds_read2_b32 v[158:159], v7 offset0:64 offset1:96
    ds_read2_b32 v[160:161], v7 offset0:128 offset1:160
    ds_read2_b32 v[162:163], v7 offset0:192 offset1:224
    ds_read2_b32 v[164:165], v8 offset0:0 offset1:32
    ds_read2_b32 v[166:167], v8 offset0:64 offset1:96
    ds_read2_b32 v[168:169], v8 offset0:128 offset1:160
    ds_read2_b32 v[170:171], v8 offset0:192 offset1:224
    v_lshlrev_b32 v25, 4, v0
    s_lshl_b32 s56, s98, 12
    v_add_u32 v25, s56, v25
    s_movk_i32 s57, 4096
    buffer_load_dwordx4 v[48:51], v25, s[24:27], 0 offen nt
    buffer_load_dwordx4 v[52:55], v25, s[24:27], s57 offen nt
    s_lshl_b32 s56, s98, 1
    v_mov_b32 v25, s56
    buffer_load_dword v58, v25, s[28:31], 0 offen
    s_lshl_b32 s60, s52, 12
    s_mov_b32 s47, 0
    s_add_u32 s56, s60, 107520
    s_mov_b32 m0, s56
    s_nop 0
    buffer_load_dwordx4 v88, s[40:43], s47 offen nt lds
    s_add_u32 s47, s47, s44
    s_add_u32 s56, s60, 108544
    s_mov_b32 m0, s56
    s_nop 0
    buffer_load_dwordx4 v89, s[40:43], s47 offen nt lds
    s_add_u32 s47, s47, s44
    s_add_u32 s56, s60, 109568
    s_mov_b32 m0, s56
    s_nop 0
    buffer_load_dwordx4 v88, s[40:43], s47 offen nt lds
    s_add_u32 s47, s47, s44
    s_add_u32 s56, s60, 110592
    s_mov_b32 m0, s56
    s_nop 0
    buffer_load_dwordx4 v89, s[40:43], s47 offen nt lds
    v_lshlrev_b32 v22, 4, v2
    s_lshl_b32 s56, s2, 13
    s_lshl_b32 s57, s52, 11
    s_add_u32 s56, s56, s57
    v_add_u32 v22, s56, v22
    buffer_load_dwordx4 v[60:63], v22, s[16:19], 0 offen nt
    buffer_load_dwordx4 v[64:67], v22, s[16:19], 0 offen offset:1024 nt
    v_lshlrev_b32 v100, 16, v44
    v_lshlrev_b32 v101, 16, v46
    v_and_b32 v102, 0xffff0000, v44
    v_and_b32 v103, 0xffff0000, v46
    v_lshlrev_b32 v104, 16, v45
    v_lshlrev_b32 v105, 16, v47
    v_and_b32 v106, 0xffff0000, v45
    v_and_b32 v107, 0xffff0000, v47
    s_waitcnt lgkmcnt(8)
    v_lshlrev_b32 v108, 16, v144
    v_and_b32 v109, 0xffff0000, v144
    v_lshlrev_b32 v110, 16, v145
    v_and_b32 v111, 0xffff0000, v145
    v_lshlrev_b32 v112, 16, v146
    v_and_b32 v113, 0xffff0000, v146
    v_lshlrev_b32 v114, 16, v147
    v_and_b32 v115, 0xffff0000, v147
    v_lshlrev_b32 v116, 16, v148
    v_and_b32 v117, 0xffff0000, v148
    v_lshlrev_b32 v118, 16, v149
    v_and_b32 v119, 0xffff0000, v149
    v_lshlrev_b32 v120, 16, v150
    v_and_b32 v121, 0xffff0000, v150
    v_lshlrev_b32 v122, 16, v151
    v_and_b32 v123, 0xffff0000, v151
    v_lshlrev_b32 v124, 16, v152
    v_and_b32 v125, 0xffff0000, v152
    v_lshlrev_b32 v126, 16, v153
    v_and_b32 v127, 0xffff0000, v153
    v_lshlrev_b32 v128, 16, v154
    v_and_b32 v129, 0xffff0000, v154
    s_waitcnt lgkmcnt(0)
    ds_write_b128 v16, v[164:167]
    ds_write_b128 v17, v[168:171]
    v_pk_mul_f32 v[180:181], v[108:109], v[106:107]
    v_pk_mul_f32 v[182:183], v[110:111], v[106:107]
    v_pk_mul_f32 v[184:185], v[112:113], v[106:107]
    v_pk_mul_f32 v[186:187], v[114:115], v[106:107]
    v_pk_mul_f32 v[188:189], v[116:117], v[106:107]
    v_pk_mul_f32 v[190:191], v[118:119], v[106:107]
    v_pk_mul_f32 v[192:193], v[120:121], v[106:107]
    v_pk_mul_f32 v[194:195], v[122:123], v[106:107]
    v_pk_fma_f32 v[180:181], v[110:111], v[104:105], v[180:181]
    v_pk_fma_f32 v[182:183], v[112:113], v[104:105], v[182:183]
    v_pk_fma_f32 v[184:185], v[114:115], v[104:105], v[184:185]
    v_pk_fma_f32 v[186:187], v[116:117], v[104:105], v[186:187]
    v_pk_fma_f32 v[188:189], v[118:119], v[104:105], v[188:189]
    v_pk_fma_f32 v[190:191], v[120:121], v[104:105], v[190:191]
    v_pk_fma_f32 v[192:193], v[122:123], v[104:105], v[192:193]
    v_pk_fma_f32 v[194:195], v[124:125], v[104:105], v[194:195]
    v_pk_fma_f32 v[180:181], v[112:113], v[102:103], v[180:181]
    v_pk_fma_f32 v[182:183], v[114:115], v[102:103], v[182:183]
    v_pk_fma_f32 v[184:185], v[116:117], v[102:103], v[184:185]
    v_pk_fma_f32 v[186:187], v[118:119], v[102:103], v[186:187]
    v_pk_fma_f32 v[188:189], v[120:121], v[102:103], v[188:189]
    v_pk_fma_f32 v[190:191], v[122:123], v[102:103], v[190:191]
    v_pk_fma_f32 v[192:193], v[124:125], v[102:103], v[192:193]
    v_pk_fma_f32 v[194:195], v[126:127], v[102:103], v[194:195]
    v_pk_fma_f32 v[180:181], v[114:115], v[100:101], v[180:181]
    v_pk_fma_f32 v[182:183], v[116:117], v[100:101], v[182:183]
    v_pk_fma_f32 v[184:185], v[118:119], v[100:101], v[184:185]
    v_pk_fma_f32 v[186:187], v[120:121], v[100:101], v[186:187]
    v_pk_fma_f32 v[188:189], v[122:123], v[100:101], v[188:189]
    v_pk_fma_f32 v[190:191], v[124:125], v[100:101], v[190:191]
    v_pk_fma_f32 v[192:193], v[126:127], v[100:101], v[192:193]
    v_pk_fma_f32 v[194:195], v[128:129], v[100:101], v[194:195]
    v_lshlrev_b32 v108, 16, v156
    v_and_b32 v109, 0xffff0000, v156
    v_lshlrev_b32 v110, 16, v157
    v_and_b32 v111, 0xffff0000, v157
    v_lshlrev_b32 v112, 16, v158
    v_and_b32 v113, 0xffff0000, v158
    v_lshlrev_b32 v114, 16, v159
    v_and_b32 v115, 0xffff0000, v159
    v_lshlrev_b32 v116, 16, v160
    v_and_b32 v117, 0xffff0000, v160
    v_lshlrev_b32 v118, 16, v161
    v_and_b32 v119, 0xffff0000, v161
    v_lshlrev_b32 v120, 16, v162
    v_and_b32 v121, 0xffff0000, v162
    v_lshlrev_b32 v122, 16, v163
    v_and_b32 v123, 0xffff0000, v163
    v_pk_mul_f32 v[180:181], v[180:181], v[108:109]
    v_pk_mul_f32 v[182:183], v[182:183], v[110:111]
    v_pk_mul_f32 v[184:185], v[184:185], v[112:113]
    v_pk_mul_f32 v[186:187], v[186:187], v[114:115]
    v_pk_mul_f32 v[188:189], v[188:189], v[116:117]
    v_pk_mul_f32 v[190:191], v[190:191], v[118:119]
    v_pk_mul_f32 v[192:193], v[192:193], v[120:121]
    v_pk_mul_f32 v[194:195], v[194:195], v[122:123]
    v_cvt_pk_bf16_f32 v172, v194, v192
    v_cvt_pk_bf16_f32 v173, v190, v188
    v_cvt_pk_bf16_f32 v174, v186, v184
    v_cvt_pk_bf16_f32 v175, v182, v180
    ds_write_b128 v15, v[172:175] offset:0
    v_cvt_pk_bf16_f32 v176, v195, v193
    v_cvt_pk_bf16_f32 v177, v191, v189
    v_cvt_pk_bf16_f32 v178, v187, v185
    v_cvt_pk_bf16_f32 v179, v183, v181
    ds_write_b128 v15, v[176:179] offset:128
    s_mov_b32 s57, 131072
    s_waitcnt lgkmcnt(0)
    s_barrier
    ds_read_b128 v[144:147], v18
    ds_read_b128 v[148:151], v18 offset:4096
    ds_read_b128 v[152:155], v20
    ds_read_b128 v[156:159], v20 offset:4096
    s_waitcnt lgkmcnt(3)
    buffer_store_dwordx4 v[144:147], v19, s[4:7], 0 offen sc1
    s_waitcnt lgkmcnt(2)
    buffer_store_dwordx4 v[148:151], v19, s[4:7], s57 offen sc1
    s_waitcnt lgkmcnt(1)
    buffer_store_dwordx4 v[152:155], v21, s[4:7], 0 offen sc1
    s_waitcnt lgkmcnt(0)
    buffer_store_dwordx4 v[156:159], v21, s[4:7], s57 offen sc1
    s_waitcnt vmcnt(10)
    v_lshlrev_b32 v9, 4, v0
    v_mov_b32 v120, 0
    v_mov_b32 v121, 0
    v_mov_b32 v122, 0
    v_mov_b32 v123, 0
    ds_write_b128 v9, v[48:51] offset:9504
    ds_write_b128 v9, v[52:55] offset:17760
    v_mul_u32_u24 v22, 2368, v4
    v_lshl_add_u32 v22, v3, 4, v22
    v_lshrrev_b32 v10, 1, v2
    v_and_b32 v10, 3, v10
    v_mul_u32_u24 v10, 4128, v10
    v_and_b32 v11, 1, v2
    v_lshl_add_u32 v10, v11, 4, v10
    ds_write_b128 v22, v[120:123] offset:2048
    ds_write_b128 v10, v[120:123] offset:9472
    v_lshlrev_b32 v70, 16, v69
    v_and_b32 v71, 0xffff0000, v69
    v_and_b32 v69, 0xffff0000, v68
    v_lshlrev_b32 v68, 16, v68
    v_mul_f32 v100, 0xbfb8aa3b, v68
    v_mul_f32 v101, 0xbfb8aa3b, v69
    v_mul_f32 v102, 0xbfb8aa3b, v70
    v_mul_f32 v103, 0xbfb8aa3b, v71
    v_exp_f32 v100, v100
    v_exp_f32 v101, v101
    v_exp_f32 v102, v102
    v_exp_f32 v103, v103
    v_add_f32 v100, 1.0, v100
    v_add_f32 v101, 1.0, v101
    v_add_f32 v102, 1.0, v102
    v_add_f32 v103, 1.0, v103
    v_rcp_f32 v100, v100
    v_rcp_f32 v101, v101
    v_rcp_f32 v102, v102
    v_rcp_f32 v103, v103
    v_mul_f32 v68, v68, v100
    v_mul_f32 v69, v69, v101
    v_mul_f32 v70, v70, v102
    v_mul_f32 v71, v71, v103
    v_cvt_pk_bf16_f32 v100, v68, v69
    v_lshlrev_b32 v68, 16, v100
    v_and_b32 v69, 0xffff0000, v100
    v_cvt_pk_bf16_f32 v100, v70, v71
    v_lshlrev_b32 v70, 16, v100
    v_and_b32 v71, 0xffff0000, v100
    v_lshlrev_b32 v112, 16, v72
    v_and_b32 v113, 0xffff0000, v72
    v_pk_mul_f32 v[104:105], v[112:113], v[68:69] op_sel_hi:[1,0]
    v_lshlrev_b32 v114, 16, v73
    v_and_b32 v115, 0xffff0000, v73
    v_pk_mul_f32 v[106:107], v[114:115], v[68:69] op_sel_hi:[1,0]
    v_lshlrev_b32 v112, 16, v74
    v_and_b32 v113, 0xffff0000, v74
    v_pk_mul_f32 v[108:109], v[112:113], v[68:69] op_sel_hi:[1,0]
    v_lshlrev_b32 v114, 16, v75
    v_and_b32 v115, 0xffff0000, v75
    v_pk_mul_f32 v[110:111], v[114:115], v[68:69] op_sel_hi:[1,0]
    v_lshlrev_b32 v112, 16, v76
    v_and_b32 v113, 0xffff0000, v76
    v_pk_fma_f32 v[104:105], v[112:113], v[68:69], v[104:105] op_sel:[0,1,0] op_sel_hi:[1,1,1]
    v_lshlrev_b32 v114, 16, v77
    v_and_b32 v115, 0xffff0000, v77
    v_pk_fma_f32 v[106:107], v[114:115], v[68:69], v[106:107] op_sel:[0,1,0] op_sel_hi:[1,1,1]
    v_lshlrev_b32 v112, 16, v78
    v_and_b32 v113, 0xffff0000, v78
    v_pk_fma_f32 v[108:109], v[112:113], v[68:69], v[108:109] op_sel:[0,1,0] op_sel_hi:[1,1,1]
    v_lshlrev_b32 v114, 16, v79
    v_and_b32 v115, 0xffff0000, v79
    v_pk_fma_f32 v[110:111], v[114:115], v[68:69], v[110:111] op_sel:[0,1,0] op_sel_hi:[1,1,1]
    v_lshlrev_b32 v112, 16, v80
    v_and_b32 v113, 0xffff0000, v80
    v_pk_fma_f32 v[104:105], v[112:113], v[70:71], v[104:105] op_sel_hi:[1,0,1]
    v_lshlrev_b32 v114, 16, v81
    v_and_b32 v115, 0xffff0000, v81
    v_pk_fma_f32 v[106:107], v[114:115], v[70:71], v[106:107] op_sel_hi:[1,0,1]
    v_lshlrev_b32 v112, 16, v82
    v_and_b32 v113, 0xffff0000, v82
    v_pk_fma_f32 v[108:109], v[112:113], v[70:71], v[108:109] op_sel_hi:[1,0,1]
    v_lshlrev_b32 v114, 16, v83
    v_and_b32 v115, 0xffff0000, v83
    v_pk_fma_f32 v[110:111], v[114:115], v[70:71], v[110:111] op_sel_hi:[1,0,1]
    v_lshlrev_b32 v112, 16, v84
    v_and_b32 v113, 0xffff0000, v84
    v_pk_fma_f32 v[104:105], v[112:113], v[70:71], v[104:105] op_sel:[0,1,0] op_sel_hi:[1,1,1]
    v_lshlrev_b32 v114, 16, v85
    v_and_b32 v115, 0xffff0000, v85
    v_pk_fma_f32 v[106:107], v[114:115], v[70:71], v[106:107] op_sel:[0,1,0] op_sel_hi:[1,1,1]
    v_lshlrev_b32 v112, 16, v86
    v_and_b32 v113, 0xffff0000, v86
    v_pk_fma_f32 v[108:109], v[112:113], v[70:71], v[108:109] op_sel:[0,1,0] op_sel_hi:[1,1,1]
    v_lshlrev_b32 v114, 16, v87
    v_and_b32 v115, 0xffff0000, v87
    v_pk_fma_f32 v[110:111], v[114:115], v[70:71], v[110:111] op_sel:[0,1,0] op_sel_hi:[1,1,1]
    v_lshrrev_b32 v11, 4, v0
    v_lshlrev_b32 v11, 8, v11
    v_and_b32 v10, 7, v0
    v_lshl_add_u32 v11, v10, 5, v11
    v_add_f32_dpp v104, v104, v104 row_shr:8 row_mask:0xf bank_mask:0xf bound_ctrl:0
    v_add_f32_dpp v105, v105, v105 row_shr:8 row_mask:0xf bank_mask:0xf bound_ctrl:0
    v_add_f32_dpp v106, v106, v106 row_shr:8 row_mask:0xf bank_mask:0xf bound_ctrl:0
    v_add_f32_dpp v107, v107, v107 row_shr:8 row_mask:0xf bank_mask:0xf bound_ctrl:0
    v_add_f32_dpp v108, v108, v108 row_shr:8 row_mask:0xf bank_mask:0xf bound_ctrl:0
    v_add_f32_dpp v109, v109, v109 row_shr:8 row_mask:0xf bank_mask:0xf bound_ctrl:0
    v_add_f32_dpp v110, v110, v110 row_shr:8 row_mask:0xf bank_mask:0xf bound_ctrl:0
    v_add_f32_dpp v111, v111, v111 row_shr:8 row_mask:0xf bank_mask:0xf bound_ctrl:0
    v_cmp_le_u32 vcc, 8, v3
    s_and_saveexec_b64 s[62:63], vcc
    ds_write_b128 v11, v[104:107] offset:25984
    ds_write_b128 v11, v[108:111] offset:26000
    s_mov_b64 exec, s[62:63]
    s_waitcnt vmcnt(0) lgkmcnt(0)
    v_readfirstlane_b32 s55, v142
    s_barrier
    s_add_u32 s55, s55, 0x9e3779b9
    s_cmp_lg_u32 s52, 0
    s_cbranch_scc1 L_fl_1
    s_lshl_b32 s56, s53, 5
    s_add_u32 s56, s56, s54
    s_lshl_b32 s56, s56, 6
    s_add_u32 s56, s56, 19922944
    v_mov_b32 v10, s56
    v_mov_b32 v11, s55
    s_mov_b64 exec, 1
    buffer_store_dword v11, v10, s[4:7], 0 offen sc1
    s_mov_b64 exec, -1
L_fl_1:
    ds_read_b64_tr_b16 v[144:145], v92
    ds_read_b64_tr_b16 v[146:147], v96
    ds_read_b64_tr_b16 v[148:149], v93
    ds_read_b64_tr_b16 v[150:151], v97
    ds_read_b64_tr_b16 v[152:153], v94
    ds_read_b64_tr_b16 v[154:155], v98
    ds_read_b64_tr_b16 v[156:157], v95
    ds_read_b64_tr_b16 v[158:159], v99
    ds_read_b32 v56, v9 offset:9500
    ds_read_b32 v57, v9 offset:17756
    s_mov_b32 s47, 0
    s_waitcnt lgkmcnt(8)
    buffer_store_dwordx4 v[144:147], v90, s[4:7], s47 offen sc1
    s_add_u32 s47, s47, s45
    s_waitcnt lgkmcnt(6)
    buffer_store_dwordx4 v[148:151], v90, s[4:7], s47 offen sc1
    s_add_u32 s47, s47, s45
    s_add_u32 s47, s47, s46
    s_waitcnt lgkmcnt(4)
    buffer_store_dwordx4 v[152:155], v90, s[4:7], s47 offen sc1
    s_add_u32 s47, s47, s45
    s_waitcnt lgkmcnt(2)
    buffer_store_dwordx4 v[156:159], v90, s[4:7], s47 offen sc1
    s_cmp_lg_u32 s52, 1
    s_cbranch_scc1 modf_done
    v_lshlrev_b32 v11, 2, v2
    ds_read_b32 v160, v11 offset:25984
    ds_read_b32 v161, v11 offset:26240
    ds_read_b32 v162, v11 offset:26496
    ds_read_b32 v163, v11 offset:26752
    ds_read_b32 v164, v11 offset:27008
    ds_read_b32 v165, v11 offset:27264
    ds_read_b32 v166, v11 offset:27520
    ds_read_b32 v167, v11 offset:27776
    ds_read_b32 v168, v11 offset:28032
    ds_read_b32 v169, v11 offset:28288
    ds_read_b32 v170, v11 offset:28544
    ds_read_b32 v171, v11 offset:28800
    ds_read_b32 v172, v11 offset:29056
    ds_read_b32 v173, v11 offset:29312
    ds_read_b32 v174, v11 offset:29568
    ds_read_b32 v175, v11 offset:29824
    s_waitcnt lgkmcnt(0)
    v_add_f32 v160, v160, v168
    v_add_f32 v161, v161, v169
    v_add_f32 v162, v162, v170
    v_add_f32 v163, v163, v171
    v_add_f32 v164, v164, v172
    v_add_f32 v165, v165, v173
    v_add_f32 v166, v166, v174
    v_add_f32 v167, v167, v175
    v_add_f32 v160, v160, v164
    v_add_f32 v161, v161, v165
    v_add_f32 v162, v162, v166
    v_add_f32 v163, v163, v167
    v_add_f32 v160, v160, v162
    v_add_f32 v161, v161, v163
    v_add_f32 v160, v160, v161
    v_add_u32 v10, s3, v11
    buffer_store_dword v160, v10, s[4:7], 0 offen sc1
modf_done:
    v_mov_b32 v100, 0
    v_mov_b32 v101, 0
    v_mov_b32 v102, 0
    v_mov_b32 v103, 0
    v_dot2_f32_bf16 v100, v60, s99, v100
    v_dot2_f32_bf16 v101, v60, v60, v101
    v_dot2_f32_bf16 v102, v64, s99, v102
    v_dot2_f32_bf16 v103, v64, v64, v103
    v_dot2_f32_bf16 v100, v61, s99, v100
    v_dot2_f32_bf16 v101, v61, v61, v101
    v_dot2_f32_bf16 v102, v65, s99, v102
    v_dot2_f32_bf16 v103, v65, v65, v103
    v_dot2_f32_bf16 v100, v62, s99, v100
    v_dot2_f32_bf16 v101, v62, v62, v101
    v_dot2_f32_bf16 v102, v66, s99, v102
    v_dot2_f32_bf16 v103, v66, v66, v103
    v_dot2_f32_bf16 v100, v63, s99, v100
    v_dot2_f32_bf16 v101, v63, v63, v101
    v_dot2_f32_bf16 v102, v67, s99, v102
    v_dot2_f32_bf16 v103, v67, v67, v103
    s_waitcnt lgkmcnt(0)
    v_alignbit_b32 v124, v48, v56, 16
    v_alignbit_b32 v125, v49, v48, 16
    v_alignbit_b32 v126, v50, v49, 16
    v_alignbit_b32 v127, v51, v50, 16
    ds_write_b128 v9, v[124:127] offset:13632
    v_alignbit_b32 v128, v52, v57, 16
    v_alignbit_b32 v129, v53, v52, 16
    v_alignbit_b32 v130, v54, v53, 16
    v_alignbit_b32 v131, v55, v54, 16
    ds_write_b128 v9, v[128:131] offset:21888
    v_add_f32_dpp v100, v100, v100 row_shr:1 row_mask:0xf bank_mask:0xf bound_ctrl:0
    v_add_f32_dpp v101, v101, v101 row_shr:1 row_mask:0xf bank_mask:0xf bound_ctrl:0
    v_add_f32_dpp v102, v102, v102 row_shr:1 row_mask:0xf bank_mask:0xf bound_ctrl:0
    v_add_f32_dpp v103, v103, v103 row_shr:1 row_mask:0xf bank_mask:0xf bound_ctrl:0
    v_add_f32_dpp v100, v100, v100 row_shr:2 row_mask:0xf bank_mask:0xf bound_ctrl:0
    v_add_f32_dpp v101, v101, v101 row_shr:2 row_mask:0xf bank_mask:0xf bound_ctrl:0
    v_add_f32_dpp v102, v102, v102 row_shr:2 row_mask:0xf bank_mask:0xf bound_ctrl:0
    v_add_f32_dpp v103, v103, v103 row_shr:2 row_mask:0xf bank_mask:0xf bound_ctrl:0
    v_add_f32_dpp v100, v100, v100 row_shr:4 row_mask:0xf bank_mask:0xf bound_ctrl:0
    v_add_f32_dpp v101, v101, v101 row_shr:4 row_mask:0xf bank_mask:0xf bound_ctrl:0
    v_add_f32_dpp v102, v102, v102 row_shr:4 row_mask:0xf bank_mask:0xf bound_ctrl:0
    v_add_f32_dpp v103, v103, v103 row_shr:4 row_mask:0xf bank_mask:0xf bound_ctrl:0
    v_add_f32_dpp v100, v100, v100 row_shr:8 row_mask:0xf bank_mask:0xf bound_ctrl:0
    v_add_f32_dpp v101, v101, v101 row_shr:8 row_mask:0xf bank_mask:0xf bound_ctrl:0
    v_add_f32_dpp v102, v102, v102 row_shr:8 row_mask:0xf bank_mask:0xf bound_ctrl:0
    v_add_f32_dpp v103, v103, v103 row_shr:8 row_mask:0xf bank_mask:0xf bound_ctrl:0
    v_add_f32_dpp v100, v100, v100 row_bcast:15 row_mask:0xa bank_mask:0xf
    v_add_f32_dpp v101, v101, v101 row_bcast:15 row_mask:0xa bank_mask:0xf
    v_add_f32_dpp v102, v102, v102 row_bcast:15 row_mask:0xa bank_mask:0xf
    v_add_f32_dpp v103, v103, v103 row_bcast:15 row_mask:0xa bank_mask:0xf
    v_add_f32_dpp v100, v100, v100 row_bcast:31 row_mask:0xc bank_mask:0xf
    v_add_f32_dpp v101, v101, v101 row_bcast:31 row_mask:0xc bank_mask:0xf
    v_add_f32_dpp v102, v102, v102 row_bcast:31 row_mask:0xc bank_mask:0xf
    v_add_f32_dpp v103, v103, v103 row_bcast:31 row_mask:0xc bank_mask:0xf
    v_mul_f32 v105, 0x3b000000, v100
    v_mul_f32 v107, 0x3b000000, v102
    v_mul_f32 v104, 0x3b000000, v101
    v_mul_f32 v106, 0x3b000000, v103
    v_fma_f32 v104, -v105, v105, v104
    v_fma_f32 v106, -v107, v107, v106
    v_max_f32 v104, 0, v104
    v_max_f32 v106, 0, v106
    v_cvt_pk_bf16_f32 v104, v104, v104
    v_cvt_pk_bf16_f32 v106, v106, v106
    v_lshlrev_b32 v104, 16, v104
    v_lshlrev_b32 v106, 16, v106
    v_cvt_pk_bf16_f32 v105, v105, v105
    v_cvt_pk_bf16_f32 v107, v107, v107
    v_lshlrev_b32 v105, 16, v105
    v_lshlrev_b32 v107, 16, v107
    v_add_f32 v104, 0x3727c5ac, v104
    v_add_f32 v106, 0x3727c5ac, v106
    v_cvt_pk_bf16_f32 v104, v104, v104
    v_cvt_pk_bf16_f32 v106, v106, v106
    v_lshlrev_b32 v104, 16, v104
    v_lshlrev_b32 v106, 16, v106
    v_sqrt_f32 v104, v104
    v_sqrt_f32 v106, v106
    s_nop 0
    v_cvt_pk_bf16_f32 v104, v104, v104
    v_cvt_pk_bf16_f32 v106, v106, v106
    v_lshlrev_b32 v104, 16, v104
    v_lshlrev_b32 v106, 16, v106
    v_rcp_f32 v104, v104
    v_rcp_f32 v106, v106
    s_nop 0
    s_lshl_b32 s56, s2, 6
    s_lshl_b32 s57, s52, 4
    s_add_u32 s56, s56, s57
    s_add_u32 s56, s56, 18939904
    v_mov_b32 v9, s56
    s_mov_b32 s62, 0
    s_mov_b32 s63, 0x80000000
    s_mov_b64 exec, s[62:63]
    buffer_store_dwordx4 v[104:107], v9, s[4:7], 0 offen sc1
    s_mov_b64 exec, -1
    s_mov_b32 s20, s80
    s_mov_b32 s21, s81
    s_mov_b32 s22, 0xac0
    s_mov_b32 s23, 0x00020000
    s_mov_b32 s28, s84
    s_mov_b32 s29, s85
    s_mov_b32 s30, 0x400
    s_mov_b32 s31, 0x00020000
    s_lshr_b32 s44, s52, 1
    s_and_b32 s45, s52, 1
    v_min_u32 v12, 31, v2
    v_lshlrev_b32 v12, 6, v12
    s_lshl_b32 s56, s53, 11
    s_add_u32 s56, s56, 19922944
    v_add_u32 v12, s56, v12
    v_lshlrev_b32 v13, 6, v2
    v_lshlrev_b32 v5, 4, v0
    s_lshl_b32 s56, s98, 12
    v_add_u32 v5, s56, v5
    v_add_u32 v6, 4096, v5
    v_and_b32 v7, 1, v0
    v_mul_u32_u24 v7, 2368, v7
    v_lshrrev_b32 v8, 1, v0
    v_lshl_add_u32 v7, v8, 4, v7
    v_lshlrev_b32 v15, 1, v4
    v_sub_u32 v15, v15, v3
    v_lshlrev_b32 v15, 4, v15
    s_mul_i32 s56, s44, 4736
    s_lshl_b32 s57, s45, 7
    s_add_u32 s56, s56, s57
    s_add_u32 s56, s56, 240
    v_add_u32 v15, s56, v15
    v_and_b32 v8, 1, v3
    v_mul_u32_u24 v8, 4130, v8
    v_lshlrev_b32 v16, 6, v4
    v_lshl_add_u32 v16, v3, 1, v16
    v_sub_u32 v16, v16, v8
    s_mul_i32 s56, s44, 8256
    s_lshl_b32 s57, s45, 8
    s_add_u32 s56, s56, s57
    s_add_u32 s56, s56, 13604
    v_add_u32 v16, s56, v16
    v_add_u32 v17, 1024, v16
    v_add_u32 v18, 2048, v16
    v_add_u32 v19, 3072, v16
    v_lshlrev_b32 v20, 16, v58
    v_and_b32 v21, 0xffff0000, v58
    v_lshlrev_b32 v8, 6, v3
    v_lshl_add_u32 v8, v4, 4, v8
    s_lshl_b32 s56, s98, 12
    s_lshl_b32 s57, s52, 11
    s_add_u32 s56, s56, s57
    v_add_u32 v14, s56, v8
    v_lshlrev_b32 v63, 1, v8
    s_lshl_b32 s56, s52, 12
    s_add_u32 s56, s56, 18939904
    v_add_u32 v63, s56, v63
    v_lshrrev_b32 v9, 2, v3
    v_cmp_eq_u32 vcc, 3, v9
    v_lshlrev_b32 v23, 11, v9
    v_and_b32 v10, 3, v3
    v_cndmask_b32 v11, 0, 1, vcc
    v_lshl_add_u32 v23, v11, 11, v23
    v_mul_u32_u24 v10, 12288, v10
    s_lshl_b32 s56, s98, 2
    s_add_u32 s56, s56, 18874368
    v_add3_u32 v23, v23, v10, s56
    v_and_b32 v9, 1, v9
    v_cvt_f32_u32 v62, v9
    v_lshlrev_b32 v10, 4, v2
    s_mul_i32 s56, s97, 11
    s_add_u32 s46, s56, s52
    s_lshl_b32 s56, s46, 14
    s_add_u32 s56, s56, 14680064
    v_add_u32 v248, s56, v10
    v_add_u32 v249, 0x10000, v248
    v_add_u32 v250, 0x20000, v248
    s_add_u32 s56, s46, 8
    s_cmp_ge_u32 s56, 86
    s_cselect_b32 s47, 1073741824, 0
    s_cmp_eq_u32 s52, 3
    s_cselect_b32 s47, 1073741824, s47
    v_add_u32 v250, s47, v250
    s_waitcnt vmcnt(0) lgkmcnt(0)
    s_barrier
    s_cmp_lg_u32 s52, 1
    s_cbranch_scc1 L_fl_2
    s_waitcnt vmcnt(0)
    s_mov_b32 s56, s2
    s_lshl_b32 s56, s56, 6
    s_add_u32 s56, s56, 19939328
    v_mov_b32 v10, s56
    v_mov_b32 v11, s55
    s_mov_b64 exec, 1
    buffer_store_dword v11, v10, s[4:7], 0 offen sc1
    s_mov_b64 exec, -1
L_fl_2:
    ds_read2_b32 v[64:65], v16 offset0:0 offset1:1
    ds_read2_b32 v[66:67], v16 offset0:2 offset1:3
    ds_read2_b32 v[68:69], v16 offset0:128 offset1:129
    ds_read2_b32 v[70:71], v16 offset0:130 offset1:131
    ds_read2_b32 v[72:73], v17 offset0:0 offset1:1
    ds_read2_b32 v[74:75], v17 offset0:2 offset1:3
    ds_read2_b32 v[76:77], v17 offset0:128 offset1:129
    ds_read2_b32 v[78:79], v17 offset0:130 offset1:131
    ds_read2_b32 v[80:81], v18 offset0:0 offset1:1
    ds_read2_b32 v[82:83], v18 offset0:2 offset1:3
    ds_read2_b32 v[84:85], v18 offset0:128 offset1:129
    ds_read2_b32 v[86:87], v18 offset0:130 offset1:131
    ds_read2_b32 v[88:89], v19 offset0:0 offset1:1
    ds_read2_b32 v[90:91], v19 offset0:2 offset1:3
    ds_read2_b32 v[92:93], v19 offset0:128 offset1:129
    ds_read2_b32 v[94:95], v19 offset0:130 offset1:131
    v_mov_b32 v24, 0
    v_mov_b32 v25, 0
    v_mov_b32 v26, 0
    v_mov_b32 v27, 0
    v_mov_b32 v28, 0
    v_mov_b32 v29, 0
    v_mov_b32 v30, 0
    v_mov_b32 v31, 0
    v_mov_b32 v32, 0
    v_mov_b32 v33, 0
    v_mov_b32 v34, 0
    v_mov_b32 v35, 0
    v_mov_b32 v36, 0
    v_mov_b32 v37, 0
    v_mov_b32 v38, 0
    v_mov_b32 v39, 0
    v_mov_b32 v40, 0
    v_mov_b32 v41, 0
    v_mov_b32 v42, 0
    v_mov_b32 v43, 0
    v_mov_b32 v44, 0
    v_mov_b32 v45, 0
    v_mov_b32 v46, 0
    v_mov_b32 v47, 0
    v_mov_b32 v48, 0
    v_mov_b32 v49, 0
    v_mov_b32 v50, 0
    v_mov_b32 v51, 0
    v_mov_b32 v52, 0
    v_mov_b32 v53, 0
    v_mov_b32 v54, 0
    v_mov_b32 v55, 0
    s_lshr_b32 s60, s54, 3
    s_mul_i32 s60, s60, 0
    s_mul_i32 s15, s97, 1
    s_lshl_b32 s14, s60, 1
    s_add_u32 s14, s14, s15
    s_lshl_b32 s14, s14, 1
    s_and_b32 s14, s14, 15
    s_add_u32 s64, s14, 0
    s_and_b32 s64, s64, 15
    s_lshl_b32 s64, s64, 10
    s_add_u32 s65, s14, 1
    s_and_b32 s65, s65, 15
    s_lshl_b32 s65, s65, 10
    s_add_u32 s66, s14, 2
    s_and_b32 s66, s66, 15
    s_lshl_b32 s66, s66, 10
    s_add_u32 s67, s14, 3
    s_and_b32 s67, s67, 15
    s_lshl_b32 s67, s67, 10
    s_add_u32 s68, s14, 4
    s_and_b32 s68, s68, 15
    s_lshl_b32 s68, s68, 10
    s_add_u32 s69, s14, 5
    s_and_b32 s69, s69, 15
    s_lshl_b32 s69, s69, 10
    s_add_u32 s70, s14, 6
    s_and_b32 s70, s70, 15
    s_lshl_b32 s70, s70, 10
    s_add_u32 s71, s14, 7
    s_and_b32 s71, s71, 15
    s_lshl_b32 s71, s71, 10
    s_add_u32 s72, s14, 8
    s_and_b32 s72, s72, 15
    s_lshl_b32 s72, s72, 10
    s_add_u32 s73, s14, 9
    s_and_b32 s73, s73, 15
    s_lshl_b32 s73, s73, 10
    s_add_u32 s74, s14, 10
    s_and_b32 s74, s74, 15
    s_lshl_b32 s74, s74, 10
    s_add_u32 s75, s14, 11
    s_and_b32 s75, s75, 15
    s_lshl_b32 s75, s75, 10
    s_add_u32 s76, s14, 12
    s_and_b32 s76, s76, 15
    s_lshl_b32 s76, s76, 10
    s_add_u32 s77, s14, 13
    s_and_b32 s77, s77, 15
    s_lshl_b32 s77, s77, 10
    s_add_u32 s78, s14, 14
    s_and_b32 s78, s78, 15
    s_lshl_b32 s78, s78, 10
    s_add_u32 s79, s14, 15
    s_and_b32 s79, s79, 15
    s_lshl_b32 s79, s79, 10
    s_mul_i32 s60, s60, 11
    s_lshr_b32 s60, s60, 1
    s_mul_i32 s61, s97, 3
    s_add_u32 s60, s60, s61
    s_cmp_ge_u32 s52, 2
    s_cselect_b32 s61, 21, 99
    s_cmp_ge_u32 s60, 22
    s_cselect_b32 s15, 22, 0
    s_sub_u32 s60, s60, s15
    s_lshl_b32 s80, s60, 12
    s_cmp_eq_u32 s60, s61
    s_cselect_b32 s80, 1073741824, s80
    s_add_u32 s60, s60, 1
    s_cmp_eq_u32 s60, 22
    s_cselect_b32 s60, 0, s60
    s_lshl_b32 s81, s60, 12
    s_cmp_eq_u32 s60, s61
    s_cselect_b32 s81, 1073741824, s81
    s_add_u32 s60, s60, 1
    s_cmp_eq_u32 s60, 22
    s_cselect_b32 s60, 0, s60
    s_lshl_b32 s82, s60, 12
    s_cmp_eq_u32 s60, s61
    s_cselect_b32 s82, 1073741824, s82
    s_add_u32 s60, s60, 1
    s_cmp_eq_u32 s60, 22
    s_cselect_b32 s60, 0, s60
    s_lshl_b32 s83, s60, 12
    s_cmp_eq_u32 s60, s61
    s_cselect_b32 s83, 1073741824, s83
    s_add_u32 s60, s60, 1
    s_cmp_eq_u32 s60, 22
    s_cselect_b32 s60, 0, s60
    s_lshl_b32 s84, s60, 12
    s_cmp_eq_u32 s60, s61
    s_cselect_b32 s84, 1073741824, s84
    s_add_u32 s60, s60, 1
    s_cmp_eq_u32 s60, 22
    s_cselect_b32 s60, 0, s60
    s_lshl_b32 s85, s60, 12
    s_cmp_eq_u32 s60, s61
    s_cselect_b32 s85, 1073741824, s85
    s_add_u32 s60, s60, 1
    s_cmp_eq_u32 s60, 22
    s_cselect_b32 s60, 0, s60
    s_lshl_b32 s86, s60, 12
    s_cmp_eq_u32 s60, s61
    s_cselect_b32 s86, 1073741824, s86
    s_add_u32 s60, s60, 1
    s_cmp_eq_u32 s60, 22
    s_cselect_b32 s60, 0, s60
    s_lshl_b32 s87, s60, 12
    s_cmp_eq_u32 s60, s61
    s_cselect_b32 s87, 1073741824, s87
    s_add_u32 s60, s60, 1
    s_cmp_eq_u32 s60, 22
    s_cselect_b32 s60, 0, s60
    s_lshl_b32 s88, s60, 12
    s_cmp_eq_u32 s60, s61
    s_cselect_b32 s88, 1073741824, s88
    s_add_u32 s60, s60, 1
    s_cmp_eq_u32 s60, 22
    s_cselect_b32 s60, 0, s60
    s_lshl_b32 s89, s60, 12
    s_cmp_eq_u32 s60, s61
    s_cselect_b32 s89, 1073741824, s89
    s_add_u32 s60, s60, 1
    s_cmp_eq_u32 s60, 22
    s_cselect_b32 s60, 0, s60
    s_lshl_b32 s90, s60, 12
    s_cmp_eq_u32 s60, s61
    s_cselect_b32 s90, 1073741824, s90
    s_add_u32 s60, s60, 1
    s_cmp_eq_u32 s60, 22
    s_cselect_b32 s60, 0, s60
    s_lshl_b32 s91, s60, 12
    s_cmp_eq_u32 s60, s61
    s_cselect_b32 s91, 1073741824, s91
    s_add_u32 s60, s60, 1
    s_cmp_eq_u32 s60, 22
    s_cselect_b32 s60, 0, s60
    s_lshl_b32 s92, s60, 12
    s_cmp_eq_u32 s60, s61
    s_cselect_b32 s92, 1073741824, s92
    s_add_u32 s60, s60, 1
    s_cmp_eq_u32 s60, 22
    s_cselect_b32 s60, 0, s60
    s_lshl_b32 s93, s60, 12
    s_cmp_eq_u32 s60, s61
    s_cselect_b32 s93, 1073741824, s93
    s_add_u32 s60, s60, 1
    s_cmp_eq_u32 s60, 22
    s_cselect_b32 s60, 0, s60
    s_lshl_b32 s94, s60, 12
    s_cmp_eq_u32 s60, s61
    s_cselect_b32 s94, 1073741824, s94
    s_add_u32 s60, s60, 1
    s_cmp_eq_u32 s60, 22
    s_cselect_b32 s60, 0, s60
    s_lshl_b32 s95, s60, 12
    s_cmp_eq_u32 s60, s61
    s_cselect_b32 s95, 1073741824, s95
    s_add_u32 s60, s60, 1
    s_cmp_eq_u32 s60, 22
    s_cselect_b32 s60, 0, s60
    s_lshl_b32 s8, s60, 12
    s_cmp_eq_u32 s60, s61
    s_cselect_b32 s8, 1073741824, s8
    s_add_u32 s60, s60, 1
    s_cmp_eq_u32 s60, 22
    s_cselect_b32 s60, 0, s60
    s_lshl_b32 s9, s60, 12
    s_cmp_eq_u32 s60, s61
    s_cselect_b32 s9, 1073741824, s9
    s_add_u32 s60, s60, 1
    s_cmp_eq_u32 s60, 22
    s_cselect_b32 s60, 0, s60
    s_lshl_b32 s10, s60, 12
    s_cmp_eq_u32 s60, s61
    s_cselect_b32 s10, 1073741824, s10
    s_add_u32 s60, s60, 1
    s_cmp_eq_u32 s60, 22
    s_cselect_b32 s60, 0, s60
    s_lshl_b32 s11, s60, 12
    s_cmp_eq_u32 s60, s61
    s_cselect_b32 s11, 1073741824, s11
    s_add_u32 s60, s60, 1
    s_cmp_eq_u32 s60, 22
    s_cselect_b32 s60, 0, s60
    s_lshl_b32 s12, s60, 12
    s_cmp_eq_u32 s60, s61
    s_cselect_b32 s12, 1073741824, s12
    s_add_u32 s60, s60, 1
    s_cmp_eq_u32 s60, 22
    s_cselect_b32 s60, 0, s60
    s_lshl_b32 s13, s60, 12
    s_cmp_eq_u32 s60, s61
    s_cselect_b32 s13, 1073741824, s13
    s_add_u32 s60, s60, 1
    s_cmp_eq_u32 s60, 22
    s_cselect_b32 s60, 0, s60
    s_cmp_lg_u32 s52, 0
    s_cbranch_scc1 p1a_done
    s_mov_b32 s56, 0
p1a:
    s_mov_b32 s57, 0
    buffer_load_dword v22, v12, s[4:7], s57 offen sc1
    s_waitcnt vmcnt(0)
    v_xor_b32 v22, s55, v22
    v_cmp_ne_u32 vcc, 0, v22
    s_add_u32 s56, s56, 1
    s_cmp_ge_u32 s56, 200000
    s_cbranch_scc1 p1a_done
    s_cbranch_vccz p1a_done
    s_mov_b64 exec, vcc
    s_sleep 2
    s_branch p1a
p1a_done:
    s_mov_b64 exec, -1
    s_barrier
    buffer_load_dwordx4 v[208:211], v5, s[4:7], 0 offen sc1
    buffer_load_dwordx4 v[212:215], v6, s[4:7], 0 offen sc1
    s_mov_b32 s58, 2097152
    buffer_load_dwordx4 v[216:219], v14, s[4:7], s58 offen offset:0 sc1
    buffer_load_dwordx4 v[220:223], v14, s[4:7], s58 offen offset:1024 sc1
    s_mov_b32 s57, 19939328
    buffer_load_dword v56, v13, s[4:7], s57 offen sc1
    s_mov_b32 s57, 19943424
    buffer_load_dword v57, v13, s[4:7], s57 offen sc1
    s_mov_b32 s57, 19947520
    buffer_load_dword v58, v13, s[4:7], s57 offen sc1
    s_mov_b32 s57, 19951616
    buffer_load_dword v59, v13, s[4:7], s57 offen sc1
    s_waitcnt vmcnt(6)
    ds_write_b128 v7, v[208:211] offset:0
    ds_write_b128 v7, v[212:215] offset:4736
    s_waitcnt lgkmcnt(0)
    s_barrier
    ds_read_b128 v[144:147], v15 offset:1792
    ds_read_b128 v[148:151], v15 offset:1536
    ds_read_b128 v[152:155], v15 offset:1280
    ds_read_b128 v[156:159], v15 offset:1024
    ds_read_b128 v[160:163], v15 offset:768
    ds_read_b128 v[164:167], v15 offset:512
    ds_read_b128 v[168:171], v15 offset:256
    ds_read_b128 v[172:175], v15 offset:0
    s_waitcnt lgkmcnt(0)
    v_mfma_f32_16x16x32_bf16 v[24:27], v[64:67], v[144:147], v[24:27]
    ds_read_b128 v[176:179], v15 offset:4160
    v_mfma_f32_16x16x32_bf16 v[28:31], v[68:71], v[144:147], v[28:31]
    ds_read_b128 v[180:183], v15 offset:3904
    v_mfma_f32_16x16x32_bf16 v[32:35], v[72:75], v[144:147], v[32:35]
    ds_read_b128 v[184:187], v15 offset:3648
    v_mfma_f32_16x16x32_bf16 v[36:39], v[76:79], v[144:147], v[36:39]
    ds_read_b128 v[188:191], v15 offset:3392
    v_mfma_f32_16x16x32_bf16 v[40:43], v[80:83], v[144:147], v[40:43]
    ds_read_b128 v[192:195], v15 offset:3136
    v_mfma_f32_16x16x32_bf16 v[44:47], v[84:87], v[144:147], v[44:47]
    ds_read_b128 v[196:199], v15 offset:2880
    v_mfma_f32_16x16x32_bf16 v[48:51], v[88:91], v[144:147], v[48:51]
    ds_read_b128 v[200:203], v15 offset:2624
    v_mfma_f32_16x16x32_bf16 v[52:55], v[92:95], v[144:147], v[52:55]
    ds_read_b128 v[204:207], v15 offset:2368
    v_mfma_f32_16x16x32_bf16 v[28:31], v[64:67], v[148:151], v[28:31]
    ds_read2_b32 v[96:97], v16 offset0:4 offset1:5
    v_mfma_f32_16x16x32_bf16 v[32:35], v[68:71], v[148:151], v[32:35]
    ds_read2_b32 v[98:99], v16 offset0:6 offset1:7
    v_mfma_f32_16x16x32_bf16 v[36:39], v[72:75], v[148:151], v[36:39]
    ds_read2_b32 v[100:101], v16 offset0:132 offset1:133
    v_mfma_f32_16x16x32_bf16 v[40:43], v[76:79], v[148:151], v[40:43]
    ds_read2_b32 v[102:103], v16 offset0:134 offset1:135
    v_mfma_f32_16x16x32_bf16 v[44:47], v[80:83], v[148:151], v[44:47]
    ds_read2_b32 v[104:105], v17 offset0:4 offset1:5
    v_mfma_f32_16x16x32_bf16 v[48:51], v[84:87], v[148:151], v[48:51]
    ds_read2_b32 v[106:107], v17 offset0:6 offset1:7
    v_mfma_f32_16x16x32_bf16 v[52:55], v[88:91], v[148:151], v[52:55]
    ds_read2_b32 v[108:109], v17 offset0:132 offset1:133
    v_mfma_f32_16x16x32_bf16 v[32:35], v[64:67], v[152:155], v[32:35]
    ds_read2_b32 v[110:111], v17 offset0:134 offset1:135
    v_mfma_f32_16x16x32_bf16 v[36:39], v[68:71], v[152:155], v[36:39]
    ds_read2_b32 v[112:113], v18 offset0:4 offset1:5
    v_mfma_f32_16x16x32_bf16 v[40:43], v[72:75], v[152:155], v[40:43]
    ds_read2_b32 v[114:115], v18 offset0:6 offset1:7
    v_mfma_f32_16x16x32_bf16 v[44:47], v[76:79], v[152:155], v[44:47]
    ds_read2_b32 v[116:117], v18 offset0:132 offset1:133
    v_mfma_f32_16x16x32_bf16 v[48:51], v[80:83], v[152:155], v[48:51]
    ds_read2_b32 v[118:119], v18 offset0:134 offset1:135
    v_mfma_f32_16x16x32_bf16 v[52:55], v[84:87], v[152:155], v[52:55]
    ds_read2_b32 v[120:121], v19 offset0:4 offset1:5
    v_mfma_f32_16x16x32_bf16 v[36:39], v[64:67], v[156:159], v[36:39]
    ds_read2_b32 v[122:123], v19 offset0:6 offset1:7
    v_mfma_f32_16x16x32_bf16 v[40:43], v[68:71], v[156:159], v[40:43]
    ds_read2_b32 v[124:125], v19 offset0:132 offset1:133
    v_mfma_f32_16x16x32_bf16 v[44:47], v[72:75], v[156:159], v[44:47]
    ds_read2_b32 v[126:127], v19 offset0:134 offset1:135
    v_mfma_f32_16x16x32_bf16 v[48:51], v[76:79], v[156:159], v[48:51]
    v_mfma_f32_16x16x32_bf16 v[52:55], v[80:83], v[156:159], v[52:55]
    v_mfma_f32_16x16x32_bf16 v[40:43], v[64:67], v[160:163], v[40:43]
    v_mfma_f32_16x16x32_bf16 v[44:47], v[68:71], v[160:163], v[44:47]
    v_mfma_f32_16x16x32_bf16 v[48:51], v[72:75], v[160:163], v[48:51]
    v_mfma_f32_16x16x32_bf16 v[52:55], v[76:79], v[160:163], v[52:55]
    v_mfma_f32_16x16x32_bf16 v[44:47], v[64:67], v[164:167], v[44:47]
    v_mfma_f32_16x16x32_bf16 v[48:51], v[68:71], v[164:167], v[48:51]
    v_mfma_f32_16x16x32_bf16 v[52:55], v[72:75], v[164:167], v[52:55]
    v_mfma_f32_16x16x32_bf16 v[48:51], v[64:67], v[168:171], v[48:51]
    v_mfma_f32_16x16x32_bf16 v[52:55], v[68:71], v[168:171], v[52:55]
    v_mfma_f32_16x16x32_bf16 v[52:55], v[64:67], v[172:175], v[52:55]
    s_waitcnt vmcnt(0)
    v_xor_b32 v56, s55, v56
    v_xor_b32 v57, s55, v57
    v_xor_b32 v58, s55, v58
    v_xor_b32 v59, s55, v59
    v_or3_b32 v56, v56, v57, v58
    v_or_b32 v56, v56, v59
    v_cmp_ne_u32 vcc, 0, v56
    s_nop 1
    s_cbranch_vccz p1b_done
    v_add_u32 v22, 19939328, v13
    s_mov_b32 s56, 0
p1b:
    s_mov_b32 s57, 0
    buffer_load_dword v56, v22, s[4:7], s57 offen sc1
    s_mov_b32 s57, 4096
    buffer_load_dword v57, v22, s[4:7], s57 offen sc1
    s_mov_b32 s57, 8192
    buffer_load_dword v58, v22, s[4:7], s57 offen sc1
    s_mov_b32 s57, 12288
    buffer_load_dword v59, v22, s[4:7], s57 offen sc1
    s_waitcnt vmcnt(0)
    v_xor_b32 v56, s55, v56
    v_xor_b32 v57, s55, v57
    v_xor_b32 v58, s55, v58
    v_xor_b32 v59, s55, v59
    v_or_b32 v56, v56, v57
    v_or_b32 v56, v56, v58
    v_or_b32 v56, v56, v59
    v_cmp_ne_u32 vcc, 0, v56
    s_add_u32 s56, s56, 1
    s_cmp_ge_u32 s56, 200000
    s_cbranch_scc1 p1b_done
    s_cbranch_vccz p1b_done
    s_mov_b64 exec, vcc
    s_sleep 2
    s_branch p1b
p1b_done:
    s_mov_b64 exec, -1
    buffer_load_dwordx2 v[208:209], v23, s[4:7], 0 offen sc1
    buffer_load_dwordx4 v[224:227], v63, s[4:7], 0 offen offset:0 sc1
    buffer_load_dwordx4 v[228:231], v63, s[4:7], 0 offen offset:16 sc1
    buffer_load_dwordx4 v[232:235], v63, s[4:7], 0 offen offset:2048 sc1
    buffer_load_dwordx4 v[236:239], v63, s[4:7], 0 offen offset:2064 sc1
    v_lshlrev_b32 v128, 3, v0
    v_add_u32 v128, 18880512, v128
    v_lshlrev_b32 v129, 3, v4
    s_lshl_b32 s56, s46, 5
    v_add_u32 v129, s56, v129
    v_lshlrev_b32 v130, 3, v3
    s_lshl_b32 s56, s96, 9
    s_lshl_b32 s57, s52, 7
    s_add_u32 s56, s56, s57
    s_add_u32 s56, s56, 18939908
    v_add_u32 v130, s56, v130
    s_mov_b32 s57, 0
    s_mov_b32 s56, 4096
    buffer_load_dwordx2 a[192:193], v128, s[4:7], s57 offen offset:0 sc1
    buffer_load_dwordx2 a[200:201], v128, s[4:7], s57 offen offset:2048 sc1
    buffer_load_dwordx2 a[208:209], v128, s[4:7], s56 offen offset:0 sc1
    s_mov_b32 s57, 12288
    s_mov_b32 s56, 16384
    buffer_load_dwordx2 a[194:195], v128, s[4:7], s57 offen offset:0 sc1
    buffer_load_dwordx2 a[202:203], v128, s[4:7], s57 offen offset:2048 sc1
    buffer_load_dwordx2 a[210:211], v128, s[4:7], s56 offen offset:0 sc1
    s_mov_b32 s57, 24576
    s_mov_b32 s56, 28672
    buffer_load_dwordx2 a[196:197], v128, s[4:7], s57 offen offset:0 sc1
    buffer_load_dwordx2 a[204:205], v128, s[4:7], s57 offen offset:2048 sc1
    buffer_load_dwordx2 a[212:213], v128, s[4:7], s56 offen offset:0 sc1
    s_mov_b32 s57, 36864
    s_mov_b32 s56, 40960
    buffer_load_dwordx2 a[198:199], v128, s[4:7], s57 offen offset:0 sc1
    buffer_load_dwordx2 a[206:207], v128, s[4:7], s57 offen offset:2048 sc1
    buffer_load_dwordx2 a[214:215], v128, s[4:7], s56 offen offset:0 sc1
    buffer_load_dwordx2 a[216:217], v129, s[20:23], 0 offen offset:0
    buffer_load_dwordx2 a[218:219], v129, s[20:23], 0 offen offset:128
    buffer_load_dwordx2 a[220:221], v129, s[20:23], 0 offen offset:256
    buffer_load_dword v140, v130, s[4:7], 0 offen sc1
    s_waitcnt lgkmcnt(0)
    v_mfma_f32_16x16x32_bf16 v[24:27], v[96:99], v[176:179], v[24:27]
    ds_read_b128 v[144:147], v15 offset:1808
    v_mfma_f32_16x16x32_bf16 v[28:31], v[100:103], v[176:179], v[28:31]
    ds_read_b128 v[148:151], v15 offset:1552
    v_mfma_f32_16x16x32_bf16 v[32:35], v[104:107], v[176:179], v[32:35]
    ds_read_b128 v[152:155], v15 offset:1296
    v_mfma_f32_16x16x32_bf16 v[36:39], v[108:111], v[176:179], v[36:39]
    ds_read_b128 v[156:159], v15 offset:1040
    v_mfma_f32_16x16x32_bf16 v[40:43], v[112:115], v[176:179], v[40:43]
    ds_read_b128 v[160:163], v15 offset:784
    v_mfma_f32_16x16x32_bf16 v[44:47], v[116:119], v[176:179], v[44:47]
    ds_read_b128 v[164:167], v15 offset:528
    buffer_load_dwordx4 a[0:3], v248, s[4:7], s64 offen sc1
    v_mfma_f32_16x16x32_bf16 v[48:51], v[120:123], v[176:179], v[48:51]
    ds_read_b128 v[168:171], v15 offset:272
    v_mfma_f32_16x16x32_bf16 v[52:55], v[124:127], v[176:179], v[52:55]
    ds_read_b128 v[172:175], v15 offset:16
    v_mfma_f32_16x16x32_bf16 v[28:31], v[96:99], v[180:183], v[28:31]
    ds_read2_b32 v[64:65], v16 offset0:8 offset1:9
    v_mfma_f32_16x16x32_bf16 v[32:35], v[100:103], v[180:183], v[32:35]
    ds_read2_b32 v[66:67], v16 offset0:10 offset1:11
    v_mfma_f32_16x16x32_bf16 v[36:39], v[104:107], v[180:183], v[36:39]
    ds_read2_b32 v[68:69], v16 offset0:136 offset1:137
    v_mfma_f32_16x16x32_bf16 v[40:43], v[108:111], v[180:183], v[40:43]
    ds_read2_b32 v[70:71], v16 offset0:138 offset1:139
    buffer_load_dwordx4 a[4:7], v249, s[4:7], s64 offen sc1
    v_mfma_f32_16x16x32_bf16 v[44:47], v[112:115], v[180:183], v[44:47]
    ds_read2_b32 v[72:73], v17 offset0:8 offset1:9
    v_mfma_f32_16x16x32_bf16 v[48:51], v[116:119], v[180:183], v[48:51]
    ds_read2_b32 v[74:75], v17 offset0:10 offset1:11
    v_mfma_f32_16x16x32_bf16 v[52:55], v[120:123], v[180:183], v[52:55]
    ds_read2_b32 v[76:77], v17 offset0:136 offset1:137
    v_mfma_f32_16x16x32_bf16 v[32:35], v[96:99], v[184:187], v[32:35]
    ds_read2_b32 v[78:79], v17 offset0:138 offset1:139
    v_mfma_f32_16x16x32_bf16 v[36:39], v[100:103], v[184:187], v[36:39]
    ds_read2_b32 v[80:81], v18 offset0:8 offset1:9
    v_mfma_f32_16x16x32_bf16 v[40:43], v[104:107], v[184:187], v[40:43]
    ds_read2_b32 v[82:83], v18 offset0:10 offset1:11
    buffer_load_dwordx4 a[8:11], v250, s[4:7], s64 offen sc1
    v_mfma_f32_16x16x32_bf16 v[44:47], v[108:111], v[184:187], v[44:47]
    ds_read2_b32 v[84:85], v18 offset0:136 offset1:137
    v_mfma_f32_16x16x32_bf16 v[48:51], v[112:115], v[184:187], v[48:51]
    ds_read2_b32 v[86:87], v18 offset0:138 offset1:139
    v_mfma_f32_16x16x32_bf16 v[52:55], v[116:119], v[184:187], v[52:55]
    ds_read2_b32 v[88:89], v19 offset0:8 offset1:9
    v_mfma_f32_16x16x32_bf16 v[36:39], v[96:99], v[188:191], v[36:39]
    ds_read2_b32 v[90:91], v19 offset0:10 offset1:11
    v_mfma_f32_16x16x32_bf16 v[40:43], v[100:103], v[188:191], v[40:43]
    ds_read2_b32 v[92:93], v19 offset0:136 offset1:137
    v_mfma_f32_16x16x32_bf16 v[44:47], v[104:107], v[188:191], v[44:47]
    ds_read2_b32 v[94:95], v19 offset0:138 offset1:139
    buffer_load_dwordx4 a[12:15], v248, s[4:7], s65 offen sc1
    v_mfma_f32_16x16x32_bf16 v[48:51], v[108:111], v[188:191], v[48:51]
    v_mfma_f32_16x16x32_bf16 v[52:55], v[112:115], v[188:191], v[52:55]
    v_mfma_f32_16x16x32_bf16 v[40:43], v[96:99], v[192:195], v[40:43]
    v_mfma_f32_16x16x32_bf16 v[44:47], v[100:103], v[192:195], v[44:47]
    v_mfma_f32_16x16x32_bf16 v[48:51], v[104:107], v[192:195], v[48:51]
    v_mfma_f32_16x16x32_bf16 v[52:55], v[108:111], v[192:195], v[52:55]
    buffer_load_dwordx4 a[16:19], v249, s[4:7], s65 offen sc1
    v_mfma_f32_16x16x32_bf16 v[44:47], v[96:99], v[196:199], v[44:47]
    v_mfma_f32_16x16x32_bf16 v[48:51], v[100:103], v[196:199], v[48:51]
    v_mfma_f32_16x16x32_bf16 v[52:55], v[104:107], v[196:199], v[52:55]
    v_mfma_f32_16x16x32_bf16 v[48:51], v[96:99], v[200:203], v[48:51]
    v_mfma_f32_16x16x32_bf16 v[52:55], v[100:103], v[200:203], v[52:55]
    v_mfma_f32_16x16x32_bf16 v[52:55], v[96:99], v[204:207], v[52:55]
    buffer_load_dwordx4 a[20:23], v250, s[4:7], s65 offen sc1
    s_waitcnt lgkmcnt(0)
    v_mfma_f32_16x16x32_bf16 v[24:27], v[64:67], v[144:147], v[24:27]
    ds_read_b128 v[176:179], v15 offset:4176
    v_mfma_f32_16x16x32_bf16 v[28:31], v[68:71], v[144:147], v[28:31]
    ds_read_b128 v[180:183], v15 offset:3920
    v_mfma_f32_16x16x32_bf16 v[32:35], v[72:75], v[144:147], v[32:35]
    ds_read_b128 v[184:187], v15 offset:3664
    v_mfma_f32_16x16x32_bf16 v[36:39], v[76:79], v[144:147], v[36:39]
    ds_read_b128 v[188:191], v15 offset:3408
    v_mfma_f32_16x16x32_bf16 v[40:43], v[80:83], v[144:147], v[40:43]
    ds_read_b128 v[192:195], v15 offset:3152
    v_mfma_f32_16x16x32_bf16 v[44:47], v[84:87], v[144:147], v[44:47]
    ds_read_b128 v[196:199], v15 offset:2896
    buffer_load_dwordx4 a[24:27], v248, s[4:7], s66 offen sc1
    v_mfma_f32_16x16x32_bf16 v[48:51], v[88:91], v[144:147], v[48:51]
    ds_read_b128 v[200:203], v15 offset:2640
    v_mfma_f32_16x16x32_bf16 v[52:55], v[92:95], v[144:147], v[52:55]
    ds_read_b128 v[204:207], v15 offset:2384
    v_mfma_f32_16x16x32_bf16 v[28:31], v[64:67], v[148:151], v[28:31]
    ds_read2_b32 v[96:97], v16 offset0:12 offset1:13
    v_mfma_f32_16x16x32_bf16 v[32:35], v[68:71], v[148:151], v[32:35]
    ds_read2_b32 v[98:99], v16 offset0:14 offset1:15
    v_mfma_f32_16x16x32_bf16 v[36:39], v[72:75], v[148:151], v[36:39]
    ds_read2_b32 v[100:101], v16 offset0:140 offset1:141
    v_mfma_f32_16x16x32_bf16 v[40:43], v[76:79], v[148:151], v[40:43]
    ds_read2_b32 v[102:103], v16 offset0:142 offset1:143
    buffer_load_dwordx4 a[28:31], v249, s[4:7], s66 offen sc1
    v_mfma_f32_16x16x32_bf16 v[44:47], v[80:83], v[148:151], v[44:47]
    ds_read2_b32 v[104:105], v17 offset0:12 offset1:13
    v_mfma_f32_16x16x32_bf16 v[48:51], v[84:87], v[148:151], v[48:51]
    ds_read2_b32 v[106:107], v17 offset0:14 offset1:15
    v_mfma_f32_16x16x32_bf16 v[52:55], v[88:91], v[148:151], v[52:55]
    ds_read2_b32 v[108:109], v17 offset0:140 offset1:141
    v_mfma_f32_16x16x32_bf16 v[32:35], v[64:67], v[152:155], v[32:35]
    ds_read2_b32 v[110:111], v17 offset0:142 offset1:143
    v_mfma_f32_16x16x32_bf16 v[36:39], v[68:71], v[152:155], v[36:39]
    ds_read2_b32 v[112:113], v18 offset0:12 offset1:13
    v_mfma_f32_16x16x32_bf16 v[40:43], v[72:75], v[152:155], v[40:43]
    ds_read2_b32 v[114:115], v18 offset0:14 offset1:15
    buffer_load_dwordx4 a[32:35], v250, s[4:7], s66 offen sc1
    v_mfma_f32_16x16x32_bf16 v[44:47], v[76:79], v[152:155], v[44:47]
    ds_read2_b32 v[116:117], v18 offset0:140 offset1:141
    v_mfma_f32_16x16x32_bf16 v[48:51], v[80:83], v[152:155], v[48:51]
    ds_read2_b32 v[118:119], v18 offset0:142 offset1:143
    v_mfma_f32_16x16x32_bf16 v[52:55], v[84:87], v[152:155], v[52:55]
    ds_read2_b32 v[120:121], v19 offset0:12 offset1:13
    v_mfma_f32_16x16x32_bf16 v[36:39], v[64:67], v[156:159], v[36:39]
    ds_read2_b32 v[122:123], v19 offset0:14 offset1:15
    v_mfma_f32_16x16x32_bf16 v[40:43], v[68:71], v[156:159], v[40:43]
    ds_read2_b32 v[124:125], v19 offset0:140 offset1:141
    v_mfma_f32_16x16x32_bf16 v[44:47], v[72:75], v[156:159], v[44:47]
    ds_read2_b32 v[126:127], v19 offset0:142 offset1:143
    buffer_load_dwordx4 a[36:39], v248, s[4:7], s67 offen sc1
    v_mfma_f32_16x16x32_bf16 v[48:51], v[76:79], v[156:159], v[48:51]
    v_mfma_f32_16x16x32_bf16 v[52:55], v[80:83], v[156:159], v[52:55]
    v_mfma_f32_16x16x32_bf16 v[40:43], v[64:67], v[160:163], v[40:43]
    v_mfma_f32_16x16x32_bf16 v[44:47], v[68:71], v[160:163], v[44:47]
    v_mfma_f32_16x16x32_bf16 v[48:51], v[72:75], v[160:163], v[48:51]
    v_mfma_f32_16x16x32_bf16 v[52:55], v[76:79], v[160:163], v[52:55]
    buffer_load_dwordx4 a[40:43], v249, s[4:7], s67 offen sc1
    v_mfma_f32_16x16x32_bf16 v[44:47], v[64:67], v[164:167], v[44:47]
    v_mfma_f32_16x16x32_bf16 v[48:51], v[68:71], v[164:167], v[48:51]
    v_mfma_f32_16x16x32_bf16 v[52:55], v[72:75], v[164:167], v[52:55]
    v_mfma_f32_16x16x32_bf16 v[48:51], v[64:67], v[168:171], v[48:51]
    v_mfma_f32_16x16x32_bf16 v[52:55], v[68:71], v[168:171], v[52:55]
    v_mfma_f32_16x16x32_bf16 v[52:55], v[64:67], v[172:175], v[52:55]
    buffer_load_dwordx4 a[44:47], v250, s[4:7], s67 offen sc1
    s_waitcnt lgkmcnt(0)
    v_mfma_f32_16x16x32_bf16 v[24:27], v[96:99], v[176:179], v[24:27]
    s_waitcnt vmcnt(32)
    v_mfma_f32_16x16x32_bf16 v[28:31], v[100:103], v[176:179], v[28:31]
    s_nop 1
    v_mfma_f32_16x16x32_bf16 v[32:35], v[104:107], v[176:179], v[32:35]
    v_add_f32_dpp v208, v208, v208 row_shr:1 row_mask:0xf bank_mask:0xf bound_ctrl:0
    v_mfma_f32_16x16x32_bf16 v[36:39], v[108:111], v[176:179], v[36:39]
    v_add_f32_dpp v209, v209, v209 row_shr:1 row_mask:0xf bank_mask:0xf bound_ctrl:0
    v_mfma_f32_16x16x32_bf16 v[40:43], v[112:115], v[176:179], v[40:43]
    s_nop 1
    v_mfma_f32_16x16x32_bf16 v[44:47], v[116:119], v[176:179], v[44:47]
    buffer_load_dwordx4 a[48:51], v248, s[4:7], s68 offen sc1
    v_add_f32_dpp v208, v208, v208 row_shr:2 row_mask:0xf bank_mask:0xf bound_ctrl:0
    v_mfma_f32_16x16x32_bf16 v[48:51], v[120:123], v[176:179], v[48:51]
    v_add_f32_dpp v209, v209, v209 row_shr:2 row_mask:0xf bank_mask:0xf bound_ctrl:0
    v_mfma_f32_16x16x32_bf16 v[52:55], v[124:127], v[176:179], v[52:55]
    v_cvt_pk_bf16_f32 v210, v208, v209
    v_mfma_f32_16x16x32_bf16 v[28:31], v[96:99], v[180:183], v[28:31]
    v_lshlrev_b32 v208, 16, v210
    v_mfma_f32_16x16x32_bf16 v[32:35], v[100:103], v[180:183], v[32:35]
    v_and_b32 v209, 0xffff0000, v210
    v_mfma_f32_16x16x32_bf16 v[36:39], v[104:107], v[180:183], v[36:39]
    v_add_f32 v208, v208, v62
    v_mfma_f32_16x16x32_bf16 v[40:43], v[108:111], v[180:183], v[40:43]
    buffer_load_dwordx4 a[52:55], v249, s[4:7], s68 offen sc1
    v_add_f32 v209, v209, v62
    v_mfma_f32_16x16x32_bf16 v[44:47], v[112:115], v[180:183], v[44:47]
    v_cvt_pk_bf16_f32 v210, v208, v209
    v_mfma_f32_16x16x32_bf16 v[48:51], v[116:119], v[180:183], v[48:51]
    v_lshlrev_b32 v208, 16, v210
    v_mfma_f32_16x16x32_bf16 v[52:55], v[120:123], v[180:183], v[52:55]
    v_and_b32 v209, 0xffff0000, v210
    v_mfma_f32_16x16x32_bf16 v[32:35], v[96:99], v[184:187], v[32:35]
    s_nop 1
    v_mfma_f32_16x16x32_bf16 v[36:39], v[100:103], v[184:187], v[36:39]
    v_mov_b32_dpp v240, v208 row_newbcast:3 row_mask:0xf bank_mask:0xf
    v_mfma_f32_16x16x32_bf16 v[40:43], v[104:107], v[184:187], v[40:43]
    buffer_load_dwordx4 a[56:59], v250, s[4:7], s68 offen sc1
    v_mov_b32_dpp v241, v209 row_newbcast:3 row_mask:0xf bank_mask:0xf
    v_mfma_f32_16x16x32_bf16 v[44:47], v[108:111], v[184:187], v[44:47]
    v_mov_b32_dpp v242, v208 row_newbcast:7 row_mask:0xf bank_mask:0xf
    v_mfma_f32_16x16x32_bf16 v[48:51], v[112:115], v[184:187], v[48:51]
    v_mov_b32_dpp v243, v209 row_newbcast:7 row_mask:0xf bank_mask:0xf
    v_mfma_f32_16x16x32_bf16 v[52:55], v[116:119], v[184:187], v[52:55]
    v_mov_b32_dpp v244, v208 row_newbcast:11 row_mask:0xf bank_mask:0xf
    v_mfma_f32_16x16x32_bf16 v[36:39], v[96:99], v[188:191], v[36:39]
    v_mov_b32_dpp v245, v209 row_newbcast:11 row_mask:0xf bank_mask:0xf
    v_mfma_f32_16x16x32_bf16 v[40:43], v[100:103], v[188:191], v[40:43]
    v_mov_b32_dpp v246, v208 row_newbcast:15 row_mask:0xf bank_mask:0xf
    v_mfma_f32_16x16x32_bf16 v[44:47], v[104:107], v[188:191], v[44:47]
    buffer_load_dwordx4 a[60:63], v248, s[4:7], s69 offen sc1
    v_mov_b32_dpp v247, v209 row_newbcast:15 row_mask:0xf bank_mask:0xf
    v_mfma_f32_16x16x32_bf16 v[48:51], v[108:111], v[188:191], v[48:51]
    v_mfma_f32_16x16x32_bf16 v[52:55], v[112:115], v[188:191], v[52:55]
    v_mfma_f32_16x16x32_bf16 v[40:43], v[96:99], v[192:195], v[40:43]
    v_mfma_f32_16x16x32_bf16 v[44:47], v[100:103], v[192:195], v[44:47]
    v_mfma_f32_16x16x32_bf16 v[48:51], v[104:107], v[192:195], v[48:51]
    v_mfma_f32_16x16x32_bf16 v[52:55], v[108:111], v[192:195], v[52:55]
    buffer_load_dwordx4 a[64:67], v249, s[4:7], s69 offen sc1
    v_mfma_f32_16x16x32_bf16 v[44:47], v[96:99], v[196:199], v[44:47]
    v_mfma_f32_16x16x32_bf16 v[48:51], v[100:103], v[196:199], v[48:51]
    v_mfma_f32_16x16x32_bf16 v[52:55], v[104:107], v[196:199], v[52:55]
    v_mfma_f32_16x16x32_bf16 v[48:51], v[96:99], v[200:203], v[48:51]
    v_mfma_f32_16x16x32_bf16 v[52:55], v[100:103], v[200:203], v[52:55]
    v_mfma_f32_16x16x32_bf16 v[52:55], v[96:99], v[204:207], v[52:55]
    buffer_load_dwordx4 a[68:71], v250, s[4:7], s69 offen sc1
    v_lshlrev_b32 v9, 4, v2
    s_lshl_b32 s56, s52, 13
    s_add_u32 s56, s56, 65536
    v_add_u32 v10, s56, v9
    s_lshl_b32 s56, s52, 11
    s_add_u32 s56, s56, 65536
    v_add_u32 v11, s56, v9
    v_lshrrev_b32 v5, 1, v4
    v_sub_u32 v5, 1, v5
    v_mul_u32_u24 v5, 2368, v5
    v_lshlrev_b32 v6, 4, v3
    v_sub_u32 v5, v5, v6
    v_and_b32 v6, 1, v4
    v_lshlrev_b32 v6, 3, v6
    v_sub_u32 v5, v5, v6
    s_lshl_b32 s56, s52, 9
    s_sub_u32 s56, 1784, s56
    v_add_u32 v5, s56, v5
    ds_write_b128 v10, v[24:27] offset:0
    ds_write_b128 v10, v[28:31] offset:1024
    ds_write_b128 v10, v[32:35] offset:2048
    ds_write_b128 v10, v[36:39] offset:3072
    ds_write_b128 v10, v[40:43] offset:4096
    ds_write_b128 v10, v[44:47] offset:5120
    ds_write_b128 v10, v[48:51] offset:6144
    ds_write_b128 v10, v[52:55] offset:7168
    ds_read_b64 v[128:129], v5 offset:256
    ds_read_b64 v[130:131], v5 offset:4992
    ds_read_b64 v[132:133], v5 offset:0
    ds_read_b64 v[134:135], v5 offset:4736
    s_waitcnt lgkmcnt(0)
    s_barrier
    ds_read_b128 v[64:67], v11 offset:0
    ds_read_b128 v[68:71], v11 offset:8192
    ds_read_b128 v[72:75], v11 offset:16384
    ds_read_b128 v[76:79], v11 offset:24576
    ds_read_b128 v[80:83], v11 offset:1024
    ds_read_b128 v[84:87], v11 offset:9216
    ds_read_b128 v[88:91], v11 offset:17408
    ds_read_b128 v[92:95], v11 offset:25600
    s_waitcnt vmcnt(34)
    s_mov_b32 s58, 6291456
    s_mov_b32 s59, 4194304
    s_waitcnt lgkmcnt(4)
    v_and_b32 v32, 0xffff0000, v129
    v_lshlrev_b32 v42, 16, v129
    v_and_b32 v52, 0xffff0000, v128
    v_lshlrev_b32 v62, 16, v128
    buffer_load_dwordx4 a[72:75], v248, s[4:7], s70 offen sc1
    v_and_b32 v33, 0xffff0000, v131
    v_lshlrev_b32 v43, 16, v131
    v_and_b32 v53, 0xffff0000, v130
    v_lshlrev_b32 v63, 16, v130
    buffer_load_dwordx4 a[76:79], v249, s[4:7], s70 offen sc1
    v_add_f32 v24, v64, v68
    v_add_f32 v34, v65, v69
    v_add_f32 v44, v66, v70
    v_add_f32 v54, v67, v71
    buffer_load_dwordx4 a[80:83], v250, s[4:7], s70 offen sc1
    v_add_f32 v25, v72, v76
    v_add_f32 v35, v73, v77
    v_add_f32 v45, v74, v78
    v_add_f32 v55, v75, v79
    buffer_load_dwordx4 a[84:87], v248, s[4:7], s71 offen sc1
    v_lshlrev_b32 v26, 16, v216
    v_lshlrev_b32 v36, 16, v217
    v_lshlrev_b32 v46, 16, v218
    v_lshlrev_b32 v56, 16, v219
    buffer_load_dwordx4 a[88:91], v249, s[4:7], s71 offen sc1
    v_and_b32 v27, 0xffff0000, v216
    v_and_b32 v37, 0xffff0000, v217
    v_and_b32 v47, 0xffff0000, v218
    v_and_b32 v57, 0xffff0000, v219
    buffer_load_dwordx4 a[92:95], v250, s[4:7], s71 offen sc1
    v_pk_fma_f32 v[24:25], v[32:33], v[20:21], v[24:25]
    v_pk_fma_f32 v[34:35], v[42:43], v[20:21], v[34:35]
    v_pk_fma_f32 v[44:45], v[52:53], v[20:21], v[44:45]
    v_pk_fma_f32 v[54:55], v[62:63], v[20:21], v[54:55]
    buffer_load_dwordx4 a[96:99], v248, s[4:7], s72 offen sc1
    v_pk_add_f32 v[28:29], v[26:27], v[224:225] op_sel:[0,1] op_sel_hi:[1,1] neg_lo:[0,1] neg_hi:[0,1]
    v_pk_add_f32 v[38:39], v[36:37], v[226:227] op_sel:[0,1] op_sel_hi:[1,1] neg_lo:[0,1] neg_hi:[0,1]
    v_pk_add_f32 v[48:49], v[46:47], v[228:229] op_sel:[0,1] op_sel_hi:[1,1] neg_lo:[0,1] neg_hi:[0,1]
    v_pk_add_f32 v[58:59], v[56:57], v[230:231] op_sel:[0,1] op_sel_hi:[1,1] neg_lo:[0,1] neg_hi:[0,1]
    buffer_load_dwordx4 a[100:103], v249, s[4:7], s72 offen sc1
    v_pk_mul_f32 v[30:31], v[28:29], v[224:225] op_sel_hi:[1,0]
    v_pk_mul_f32 v[40:41], v[38:39], v[226:227] op_sel_hi:[1,0]
    v_pk_mul_f32 v[50:51], v[48:49], v[228:229] op_sel_hi:[1,0]
    v_pk_mul_f32 v[60:61], v[58:59], v[230:231] op_sel_hi:[1,0]
    v_pk_fma_f32 v[30:31], v[30:31], v[242:243], v[240:241]
    v_pk_fma_f32 v[40:41], v[40:41], v[242:243], v[240:241]
    v_pk_fma_f32 v[50:51], v[50:51], v[242:243], v[240:241]
    v_pk_fma_f32 v[60:61], v[60:61], v[242:243], v[240:241]
    v_pk_mul_f32 v[30:31], v[30:31], v[24:25]
    v_pk_mul_f32 v[40:41], v[40:41], v[34:35]
    v_pk_mul_f32 v[50:51], v[50:51], v[44:45]
    v_pk_mul_f32 v[60:61], v[60:61], v[54:55]
    v_pk_fma_f32 v[28:29], v[30:31], v[244:245], v[28:29]
    v_pk_fma_f32 v[38:39], v[40:41], v[244:245], v[38:39]
    v_pk_fma_f32 v[48:49], v[50:51], v[244:245], v[48:49]
    v_pk_fma_f32 v[58:59], v[60:61], v[244:245], v[58:59]
    v_pk_fma_f32 v[26:27], v[30:31], v[244:245], v[26:27]
    v_pk_fma_f32 v[36:37], v[40:41], v[244:245], v[36:37]
    v_pk_fma_f32 v[46:47], v[50:51], v[244:245], v[46:47]
    v_pk_fma_f32 v[56:57], v[60:61], v[244:245], v[56:57]
    v_pk_mul_f32 v[28:29], v[28:29], v[246:247]
    v_pk_mul_f32 v[38:39], v[38:39], v[246:247]
    v_pk_mul_f32 v[48:49], v[48:49], v[246:247]
    v_pk_mul_f32 v[58:59], v[58:59], v[246:247]
    v_cvt_pk_bf16_f32 v112, v26, v27
    v_cvt_pk_bf16_f32 v113, v36, v37
    v_cvt_pk_bf16_f32 v114, v46, v47
    v_cvt_pk_bf16_f32 v115, v56, v57
    v_cvt_pk_bf16_f32 v120, v28, v29
    v_cvt_pk_bf16_f32 v121, v38, v39
    v_cvt_pk_bf16_f32 v122, v48, v49
    v_cvt_pk_bf16_f32 v123, v58, v59
    buffer_store_dwordx4 v[120:123], v14, s[4:7], s58 offen offset:0 sc1
    buffer_store_dwordx4 v[112:115], v14, s[4:7], s59 offen offset:0 sc1
    s_waitcnt lgkmcnt(0)
    v_and_b32 v32, 0xffff0000, v133
    v_lshlrev_b32 v42, 16, v133
    v_and_b32 v52, 0xffff0000, v132
    v_lshlrev_b32 v62, 16, v132
    buffer_load_dwordx4 a[104:107], v250, s[4:7], s72 offen sc1
    v_and_b32 v33, 0xffff0000, v135
    v_lshlrev_b32 v43, 16, v135
    v_and_b32 v53, 0xffff0000, v134
    v_lshlrev_b32 v63, 16, v134
    buffer_load_dwordx4 a[108:111], v248, s[4:7], s73 offen sc1
    v_add_f32 v24, v80, v84
    v_add_f32 v34, v81, v85
    v_add_f32 v44, v82, v86
    v_add_f32 v54, v83, v87
    buffer_load_dwordx4 a[112:115], v249, s[4:7], s73 offen sc1
    v_add_f32 v25, v88, v92
    v_add_f32 v35, v89, v93
    v_add_f32 v45, v90, v94
    v_add_f32 v55, v91, v95
    buffer_load_dwordx4 a[116:119], v250, s[4:7], s73 offen sc1
    v_lshlrev_b32 v26, 16, v220
    v_lshlrev_b32 v36, 16, v221
    v_lshlrev_b32 v46, 16, v222
    v_lshlrev_b32 v56, 16, v223
    buffer_load_dwordx4 a[120:123], v248, s[4:7], s74 offen sc1
    v_and_b32 v27, 0xffff0000, v220
    v_and_b32 v37, 0xffff0000, v221
    v_and_b32 v47, 0xffff0000, v222
    v_and_b32 v57, 0xffff0000, v223
    buffer_load_dwordx4 a[124:127], v249, s[4:7], s74 offen sc1
    v_pk_fma_f32 v[24:25], v[32:33], v[20:21], v[24:25]
    v_pk_fma_f32 v[34:35], v[42:43], v[20:21], v[34:35]
    v_pk_fma_f32 v[44:45], v[52:53], v[20:21], v[44:45]
    v_pk_fma_f32 v[54:55], v[62:63], v[20:21], v[54:55]
    buffer_load_dwordx4 a[128:131], v250, s[4:7], s74 offen sc1
    v_pk_add_f32 v[28:29], v[26:27], v[232:233] op_sel:[0,1] op_sel_hi:[1,1] neg_lo:[0,1] neg_hi:[0,1]
    v_pk_add_f32 v[38:39], v[36:37], v[234:235] op_sel:[0,1] op_sel_hi:[1,1] neg_lo:[0,1] neg_hi:[0,1]
    v_pk_add_f32 v[48:49], v[46:47], v[236:237] op_sel:[0,1] op_sel_hi:[1,1] neg_lo:[0,1] neg_hi:[0,1]
    v_pk_add_f32 v[58:59], v[56:57], v[238:239] op_sel:[0,1] op_sel_hi:[1,1] neg_lo:[0,1] neg_hi:[0,1]
    buffer_load_dwordx4 a[132:135], v248, s[4:7], s75 offen sc1
    v_pk_mul_f32 v[30:31], v[28:29], v[232:233] op_sel_hi:[1,0]
    v_pk_mul_f32 v[40:41], v[38:39], v[234:235] op_sel_hi:[1,0]
    v_pk_mul_f32 v[50:51], v[48:49], v[236:237] op_sel_hi:[1,0]
    v_pk_mul_f32 v[60:61], v[58:59], v[238:239] op_sel_hi:[1,0]
    v_pk_fma_f32 v[30:31], v[30:31], v[242:243], v[240:241]
    v_pk_fma_f32 v[40:41], v[40:41], v[242:243], v[240:241]
    v_pk_fma_f32 v[50:51], v[50:51], v[242:243], v[240:241]
    v_pk_fma_f32 v[60:61], v[60:61], v[242:243], v[240:241]
    v_pk_mul_f32 v[30:31], v[30:31], v[24:25]
    v_pk_mul_f32 v[40:41], v[40:41], v[34:35]
    v_pk_mul_f32 v[50:51], v[50:51], v[44:45]
    v_pk_mul_f32 v[60:61], v[60:61], v[54:55]
    v_pk_fma_f32 v[28:29], v[30:31], v[244:245], v[28:29]
    v_pk_fma_f32 v[38:39], v[40:41], v[244:245], v[38:39]
    v_pk_fma_f32 v[48:49], v[50:51], v[244:245], v[48:49]
    v_pk_fma_f32 v[58:59], v[60:61], v[244:245], v[58:59]
    v_pk_fma_f32 v[26:27], v[30:31], v[244:245], v[26:27]
    v_pk_fma_f32 v[36:37], v[40:41], v[244:245], v[36:37]
    v_pk_fma_f32 v[46:47], v[50:51], v[244:245], v[46:47]
    v_pk_fma_f32 v[56:57], v[60:61], v[244:245], v[56:57]
    v_pk_mul_f32 v[28:29], v[28:29], v[246:247]
    v_pk_mul_f32 v[38:39], v[38:39], v[246:247]
    v_pk_mul_f32 v[48:49], v[48:49], v[246:247]
    v_pk_mul_f32 v[58:59], v[58:59], v[246:247]
    v_cvt_pk_bf16_f32 v116, v26, v27
    v_cvt_pk_bf16_f32 v117, v36, v37
    v_cvt_pk_bf16_f32 v118, v46, v47
    v_cvt_pk_bf16_f32 v119, v56, v57
    v_cvt_pk_bf16_f32 v124, v28, v29
    v_cvt_pk_bf16_f32 v125, v38, v39
    v_cvt_pk_bf16_f32 v126, v48, v49
    v_cvt_pk_bf16_f32 v127, v58, v59
    buffer_store_dwordx4 v[124:127], v14, s[4:7], s58 offen offset:1024 sc1
    buffer_store_dwordx4 v[116:119], v14, s[4:7], s59 offen offset:1024 sc1
    buffer_load_dwordx4 a[136:139], v249, s[4:7], s75 offen sc1
    buffer_load_dwordx4 a[140:143], v250, s[4:7], s75 offen sc1
    buffer_load_dwordx4 a[144:147], v248, s[4:7], s76 offen sc1
    buffer_load_dwordx4 a[148:151], v249, s[4:7], s76 offen sc1
    buffer_load_dwordx4 a[152:155], v250, s[4:7], s76 offen sc1
    buffer_load_dwordx4 a[156:159], v248, s[4:7], s77 offen sc1
    buffer_load_dwordx4 a[160:163], v249, s[4:7], s77 offen sc1
    buffer_load_dwordx4 a[164:167], v250, s[4:7], s77 offen sc1
    buffer_load_dwordx4 a[168:171], v248, s[4:7], s78 offen sc1
    buffer_load_dwordx4 a[172:175], v249, s[4:7], s78 offen sc1
    buffer_load_dwordx4 a[176:179], v250, s[4:7], s78 offen sc1
    buffer_load_dwordx4 a[180:183], v248, s[4:7], s79 offen sc1
    buffer_load_dwordx4 a[184:187], v249, s[4:7], s79 offen sc1
    buffer_load_dwordx4 a[188:191], v250, s[4:7], s79 offen sc1
    s_waitcnt vmcnt(52)
    v_accvgpr_read_b32 v144, a192
    v_accvgpr_read_b32 v145, a193
    v_accvgpr_read_b32 v146, a194
    v_accvgpr_read_b32 v147, a195
    v_accvgpr_read_b32 v148, a196
    v_accvgpr_read_b32 v149, a197
    v_accvgpr_read_b32 v150, a198
    v_accvgpr_read_b32 v151, a199
    v_accvgpr_read_b32 v152, a200
    v_accvgpr_read_b32 v153, a201
    v_accvgpr_read_b32 v154, a202
    v_accvgpr_read_b32 v155, a203
    v_accvgpr_read_b32 v156, a204
    v_accvgpr_read_b32 v157, a205
    v_accvgpr_read_b32 v158, a206
    v_accvgpr_read_b32 v159, a207
    v_accvgpr_read_b32 v160, a208
    v_accvgpr_read_b32 v161, a209
    v_accvgpr_read_b32 v162, a210
    v_accvgpr_read_b32 v163, a211
    v_accvgpr_read_b32 v164, a212
    v_accvgpr_read_b32 v165, a213
    v_accvgpr_read_b32 v166, a214
    v_accvgpr_read_b32 v167, a215
    v_accvgpr_read_b32 v208, a216
    v_accvgpr_read_b32 v209, a217
    v_accvgpr_read_b32 v210, a218
    v_accvgpr_read_b32 v211, a219
    v_accvgpr_read_b32 v212, a220
    v_accvgpr_read_b32 v213, a221
    v_pk_add_f32 v[144:145], v[144:145], v[146:147]
    v_pk_add_f32 v[148:149], v[148:149], v[150:151]
    v_pk_add_f32 v[152:153], v[152:153], v[154:155]
    v_pk_add_f32 v[156:157], v[156:157], v[158:159]
    v_pk_add_f32 v[160:161], v[160:161], v[162:163]
    v_pk_add_f32 v[164:165], v[164:165], v[166:167]
    v_pk_add_f32 v[144:145], v[144:145], v[148:149]
    v_cvt_pk_bf16_f32 v146, v144, v145
    v_pk_add_f32 v[152:153], v[152:153], v[156:157]
    v_cvt_pk_bf16_f32 v154, v152, v153
    v_pk_add_f32 v[160:161], v[160:161], v[164:165]
    v_cvt_pk_bf16_f32 v162, v160, v161
    v_lshlrev_b32 v152, 16, v154
    v_and_b32 v153, 0xffff0000, v154
    v_lshlrev_b32 v160, 16, v162
    v_and_b32 v161, 0xffff0000, v162
    v_add_f32 v152, 1.0, v152
    v_add_f32 v153, 1.0, v153
    v_cvt_pk_bf16_f32 v154, v152, v153
    v_lshlrev_b32 v9, 2, v0
    v_add_u32 v9, 131072, v9
    v_lshlrev_b32 v10, 3, v0
    v_add_u32 v10, 135296, v10
    ds_write_b32 v9, v146
    ds_write_b32 v9, v146 offset:1024
    ds_write_b32 v9, v154 offset:2112
    ds_write_b32 v9, v154 offset:3136
    ds_write_b64 v10, v[160:161]
    v_and_b32 v9, 1, v3
    v_mul_u32_u24 v9, 2112, v9
    v_lshl_add_u32 v9, v4, 4, v9
    s_lshl_b32 s56, s14, 6
    s_add_u32 s56, s56, 131072
    v_add_u32 v9, s56, v9
    v_lshlrev_b32 v5, 13, v4
    s_lshl_b32 s56, s52, 15
    s_lshl_b32 s57, s96, 8
    s_add_u32 s56, s56, s57
    v_add_u32 v5, s56, v5
    s_and_b32 s57, s52, 1
    s_lshl_b32 s57, s57, 2
    v_xor_b32 v7, s57, v3
    v_lshl_add_u32 v5, v7, 4, v5
    v_add_u32 v6, 4194304, v5
    v_add_u32 v5, 6291456, v5
    v_and_b32 v7, 1, v4
    v_lshlrev_b32 v8, 10, v4
    v_lshl_add_u32 v8, v3, 2, v8
    v_add_u32 v8, 65536, v8
    v_xor_b32 v10, 0, v7
    v_lshl_add_u32 v16, v10, 6, v8
    v_xor_b32 v10, 1, v7
    v_lshl_add_u32 v17, v10, 6, v8
    v_xor_b32 v10, 2, v7
    v_lshl_add_u32 v18, v10, 6, v8
    v_xor_b32 v10, 3, v7
    v_lshl_add_u32 v19, v10, 6, v8
    v_xor_b32 v10, s52, v7
    v_lshl_add_u32 v141, v10, 6, v8
    v_subrev_u32 v141, 65536, v141
    v_lshlrev_b32 v10, 4, v2
    s_lshl_b32 s56, s52, 10
    v_add_u32 v11, s56, v10
    s_mul_i32 s56, s97, 176128
    s_add_u32 s56, s56, 16777216
    v_add_u32 v20, s56, v11
    v_add_u32 v21, 88064, v20
    s_mul_i32 s56, s96, 176128
    s_add_u32 s56, s56, 8388608
    v_add_u32 v22, s56, v11
    v_add_u32 v23, 88064, v22
    v_add_u32 v12, 19955712, v13
    s_mul_i32 s56, s52, 384
    s_add_u32 s56, s56, 137344
    v_lshl_add_u32 v14, v4, 4, s56
    s_waitcnt vmcnt(14) lgkmcnt(0)
    s_barrier
    s_cmp_lg_u32 s52, 0
    s_cbranch_scc1 L_fl_3
    s_mov_b32 s56, s2
    s_lshl_b32 s56, s56, 6
    s_add_u32 s56, s56, 19955712
    v_mov_b32 v10, s56
    v_mov_b32 v11, s55
    s_mov_b64 exec, 1
    buffer_store_dword v11, v10, s[4:7], 0 offen sc1
    s_mov_b64 exec, -1
L_fl_3:
    ds_read_b128 v[64:67], v9 offset:0
    ds_read_b128 v[68:71], v9 offset:64
    ds_read_b128 v[72:75], v9 offset:128
    ds_read_b128 v[76:79], v9 offset:192
    ds_read_b128 v[80:83], v9 offset:256
    ds_read_b128 v[84:87], v9 offset:320
    ds_read_b128 v[88:91], v9 offset:384
    ds_read_b128 v[92:95], v9 offset:448
    ds_read_b128 v[96:99], v9 offset:512
    ds_read_b128 v[100:103], v9 offset:576
    ds_read_b128 v[104:107], v9 offset:640
    ds_read_b128 v[108:111], v9 offset:704
    ds_read_b128 v[112:115], v9 offset:768
    ds_read_b128 v[116:119], v9 offset:832
    ds_read_b128 v[120:123], v9 offset:896
    ds_read_b128 v[124:127], v9 offset:960
    v_mov_b32 v24, 0
    v_mov_b32 v25, 0
    v_mov_b32 v26, 0
    v_mov_b32 v27, 0
    v_mov_b32 v28, 0
    v_mov_b32 v29, 0
    v_mov_b32 v30, 0
    v_mov_b32 v31, 0
    v_mov_b32 v32, 0
    v_mov_b32 v33, 0
    v_mov_b32 v34, 0
    v_mov_b32 v35, 0
    s_waitcnt lgkmcnt(0)
    v_mfma_f32_16x16x32_bf16 v[24:27], a[0:3], v[64:67], v[24:27]
    v_mfma_f32_16x16x32_bf16 v[28:31], a[4:7], v[64:67], v[28:31]
    v_mfma_f32_16x16x32_bf16 v[32:35], a[8:11], v[64:67], v[32:35]
    v_mfma_f32_16x16x32_bf16 v[24:27], a[12:15], v[68:71], v[24:27]
    v_mfma_f32_16x16x32_bf16 v[28:31], a[16:19], v[68:71], v[28:31]
    v_mfma_f32_16x16x32_bf16 v[32:35], a[20:23], v[68:71], v[32:35]
    v_mfma_f32_16x16x32_bf16 v[24:27], a[24:27], v[72:75], v[24:27]
    v_mfma_f32_16x16x32_bf16 v[28:31], a[28:31], v[72:75], v[28:31]
    v_mfma_f32_16x16x32_bf16 v[32:35], a[32:35], v[72:75], v[32:35]
    v_mfma_f32_16x16x32_bf16 v[24:27], a[36:39], v[76:79], v[24:27]
    v_mfma_f32_16x16x32_bf16 v[28:31], a[40:43], v[76:79], v[28:31]
    v_mfma_f32_16x16x32_bf16 v[32:35], a[44:47], v[76:79], v[32:35]
    v_mfma_f32_16x16x32_bf16 v[24:27], a[48:51], v[80:83], v[24:27]
    v_mfma_f32_16x16x32_bf16 v[28:31], a[52:55], v[80:83], v[28:31]
    v_mfma_f32_16x16x32_bf16 v[32:35], a[56:59], v[80:83], v[32:35]
    v_mfma_f32_16x16x32_bf16 v[24:27], a[60:63], v[84:87], v[24:27]
    v_mfma_f32_16x16x32_bf16 v[28:31], a[64:67], v[84:87], v[28:31]
    v_mfma_f32_16x16x32_bf16 v[32:35], a[68:71], v[84:87], v[32:35]
    v_mfma_f32_16x16x32_bf16 v[24:27], a[72:75], v[88:91], v[24:27]
    v_mfma_f32_16x16x32_bf16 v[28:31], a[76:79], v[88:91], v[28:31]
    v_mfma_f32_16x16x32_bf16 v[32:35], a[80:83], v[88:91], v[32:35]
    v_mfma_f32_16x16x32_bf16 v[24:27], a[84:87], v[92:95], v[24:27]
    v_mfma_f32_16x16x32_bf16 v[28:31], a[88:91], v[92:95], v[28:31]
    v_mfma_f32_16x16x32_bf16 v[32:35], a[92:95], v[92:95], v[32:35]
    v_mfma_f32_16x16x32_bf16 v[24:27], a[96:99], v[96:99], v[24:27]
    v_mfma_f32_16x16x32_bf16 v[28:31], a[100:103], v[96:99], v[28:31]
    v_mfma_f32_16x16x32_bf16 v[32:35], a[104:107], v[96:99], v[32:35]
    v_mfma_f32_16x16x32_bf16 v[24:27], a[108:111], v[100:103], v[24:27]
    v_mfma_f32_16x16x32_bf16 v[28:31], a[112:115], v[100:103], v[28:31]
    v_mfma_f32_16x16x32_bf16 v[32:35], a[116:119], v[100:103], v[32:35]
    v_mfma_f32_16x16x32_bf16 v[24:27], a[120:123], v[104:107], v[24:27]
    v_mfma_f32_16x16x32_bf16 v[28:31], a[124:127], v[104:107], v[28:31]
    v_mfma_f32_16x16x32_bf16 v[32:35], a[128:131], v[104:107], v[32:35]
    s_waitcnt vmcnt(12)
    v_mfma_f32_16x16x32_bf16 v[24:27], a[132:135], v[108:111], v[24:27]
    v_mfma_f32_16x16x32_bf16 v[28:31], a[136:139], v[108:111], v[28:31]
    v_mfma_f32_16x16x32_bf16 v[32:35], a[140:143], v[108:111], v[32:35]
    s_waitcnt vmcnt(9)
    v_mfma_f32_16x16x32_bf16 v[24:27], a[144:147], v[112:115], v[24:27]
    v_mfma_f32_16x16x32_bf16 v[28:31], a[148:151], v[112:115], v[28:31]
    v_mfma_f32_16x16x32_bf16 v[32:35], a[152:155], v[112:115], v[32:35]
    s_waitcnt vmcnt(6)
    v_mfma_f32_16x16x32_bf16 v[24:27], a[156:159], v[116:119], v[24:27]
    v_mfma_f32_16x16x32_bf16 v[28:31], a[160:163], v[116:119], v[28:31]
    v_mfma_f32_16x16x32_bf16 v[32:35], a[164:167], v[116:119], v[32:35]
    s_waitcnt vmcnt(3)
    v_mfma_f32_16x16x32_bf16 v[24:27], a[168:171], v[120:123], v[24:27]
    v_mfma_f32_16x16x32_bf16 v[28:31], a[172:175], v[120:123], v[28:31]
    v_mfma_f32_16x16x32_bf16 v[32:35], a[176:179], v[120:123], v[32:35]
    s_waitcnt vmcnt(0)
    v_mfma_f32_16x16x32_bf16 v[24:27], a[180:183], v[124:127], v[24:27]
    v_mfma_f32_16x16x32_bf16 v[28:31], a[184:187], v[124:127], v[28:31]
    v_mfma_f32_16x16x32_bf16 v[32:35], a[188:191], v[124:127], v[32:35]
    s_nop 7
    s_nop 1
    v_mov_b32_dpp v36, v24 row_newbcast:0 row_mask:0xf bank_mask:0xf
    v_mov_b32_dpp v48, v24 row_newbcast:1 row_mask:0xf bank_mask:0xf
    v_mov_b32_dpp v37, v25 row_newbcast:0 row_mask:0xf bank_mask:0xf
    v_mov_b32_dpp v49, v25 row_newbcast:1 row_mask:0xf bank_mask:0xf
    v_mov_b32_dpp v38, v26 row_newbcast:0 row_mask:0xf bank_mask:0xf
    v_mov_b32_dpp v50, v26 row_newbcast:1 row_mask:0xf bank_mask:0xf
    v_mov_b32_dpp v39, v27 row_newbcast:0 row_mask:0xf bank_mask:0xf
    v_mov_b32_dpp v51, v27 row_newbcast:1 row_mask:0xf bank_mask:0xf
    v_mov_b32_dpp v40, v28 row_newbcast:0 row_mask:0xf bank_mask:0xf
    v_mov_b32_dpp v52, v28 row_newbcast:1 row_mask:0xf bank_mask:0xf
    v_mov_b32_dpp v41, v29 row_newbcast:0 row_mask:0xf bank_mask:0xf
    v_mov_b32_dpp v53, v29 row_newbcast:1 row_mask:0xf bank_mask:0xf
    v_mov_b32_dpp v42, v30 row_newbcast:0 row_mask:0xf bank_mask:0xf
    v_mov_b32_dpp v54, v30 row_newbcast:1 row_mask:0xf bank_mask:0xf
    v_mov_b32_dpp v43, v31 row_newbcast:0 row_mask:0xf bank_mask:0xf
    v_mov_b32_dpp v55, v31 row_newbcast:1 row_mask:0xf bank_mask:0xf
    v_mov_b32_dpp v44, v32 row_newbcast:0 row_mask:0xf bank_mask:0xf
    v_mov_b32_dpp v56, v32 row_newbcast:1 row_mask:0xf bank_mask:0xf
    v_mov_b32_dpp v45, v33 row_newbcast:0 row_mask:0xf bank_mask:0xf
    v_mov_b32_dpp v57, v33 row_newbcast:1 row_mask:0xf bank_mask:0xf
    v_mov_b32_dpp v46, v34 row_newbcast:0 row_mask:0xf bank_mask:0xf
    v_mov_b32_dpp v58, v34 row_newbcast:1 row_mask:0xf bank_mask:0xf
    v_mov_b32_dpp v47, v35 row_newbcast:0 row_mask:0xf bank_mask:0xf
    v_mov_b32_dpp v59, v35 row_newbcast:1 row_mask:0xf bank_mask:0xf
    v_lshlrev_b32 v60, 16, v208
    v_and_b32 v61, 0xffff0000, v208
    v_lshlrev_b32 v62, 16, v209
    v_and_b32 v63, 0xffff0000, v209
    v_pk_add_f32 v[36:37], v[36:37], v[60:61]
    v_pk_add_f32 v[38:39], v[38:39], v[62:63]
    v_lshlrev_b32 v60, 16, v210
    v_and_b32 v61, 0xffff0000, v210
    v_lshlrev_b32 v62, 16, v211
    v_and_b32 v63, 0xffff0000, v211
    v_pk_add_f32 v[40:41], v[40:41], v[60:61]
    v_pk_add_f32 v[42:43], v[42:43], v[62:63]
    v_lshlrev_b32 v60, 16, v212
    v_and_b32 v61, 0xffff0000, v212
    v_lshlrev_b32 v62, 16, v213
    v_and_b32 v63, 0xffff0000, v213
    v_pk_add_f32 v[44:45], v[44:45], v[60:61]
    v_pk_add_f32 v[46:47], v[46:47], v[62:63]
    s_mov_b32 s62, 0x00010001
    s_mov_b32 s63, 0x00010001
    s_mov_b64 exec, s[62:63]
    ds_write_b128 v14, v[36:39] offset:0
    ds_write_b128 v14, v[40:43] offset:64
    ds_write_b128 v14, v[44:47] offset:128
    ds_write_b128 v14, v[48:51] offset:192
    ds_write_b128 v14, v[52:55] offset:256
    ds_write_b128 v14, v[56:59] offset:320
    s_mov_b64 exec, -1
    s_waitcnt lgkmcnt(0)
    v_mov_b32 v24, 0
    v_mov_b32 v25, 0
    v_mov_b32 v26, 0
    v_mov_b32 v27, 0
    v_mov_b32 v28, 0
    v_mov_b32 v29, 0
    v_mov_b32 v30, 0
    v_mov_b32 v31, 0
    v_mov_b32 v32, 0
    v_mov_b32 v33, 0
    v_mov_b32 v34, 0
    v_mov_b32 v35, 0
    v_mov_b32 v36, 0
    v_mov_b32 v37, 0
    v_mov_b32 v38, 0
    v_mov_b32 v39, 0
    v_mov_b32 v40, 0
    v_mov_b32 v41, 0
    v_mov_b32 v42, 0
    v_mov_b32 v43, 0
    v_mov_b32 v44, 0
    v_mov_b32 v45, 0
    v_mov_b32 v46, 0
    v_mov_b32 v47, 0
    v_mov_b32 v48, 0
    v_mov_b32 v49, 0
    v_mov_b32 v50, 0
    v_mov_b32 v51, 0
    v_mov_b32 v52, 0
    v_mov_b32 v53, 0
    v_mov_b32 v54, 0
    v_mov_b32 v55, 0
    v_mov_b32 v56, 0
    v_mov_b32 v57, 0
    v_mov_b32 v58, 0
    v_mov_b32 v59, 0
    v_mov_b32 v60, 0
    v_mov_b32 v61, 0
    v_mov_b32 v62, 0
    v_mov_b32 v63, 0
    v_mov_b32 v64, 0
    v_mov_b32 v65, 0
    v_mov_b32 v66, 0
    v_mov_b32 v67, 0
    v_mov_b32 v68, 0
    v_mov_b32 v69, 0
    v_mov_b32 v70, 0
    v_mov_b32 v71, 0
    s_cmp_eq_u32 s52, 0
    s_cbranch_scc1 p2w0
    s_branch p2join
p2w0:
    s_cmp_lg_u32 s52, 0
    s_cbranch_scc1 p2_done
    s_mov_b32 s56, 0
p2:
    s_mov_b32 s57, 0
    buffer_load_dword v136, v12, s[4:7], s57 offen sc1
    s_mov_b32 s57, 4096
    buffer_load_dword v137, v12, s[4:7], s57 offen sc1
    s_mov_b32 s57, 8192
    buffer_load_dword v138, v12, s[4:7], s57 offen sc1
    s_mov_b32 s57, 12288
    buffer_load_dword v139, v12, s[4:7], s57 offen sc1
    s_waitcnt vmcnt(0)
    v_xor_b32 v136, s55, v136
    v_xor_b32 v137, s55, v137
    v_xor_b32 v138, s55, v138
    v_xor_b32 v139, s55, v139
    v_or_b32 v136, v136, v137
    v_or_b32 v136, v136, v138
    v_or_b32 v136, v136, v139
    v_cmp_ne_u32 vcc, 0, v136
    s_add_u32 s56, s56, 1
    s_cmp_ge_u32 s56, 200000
    s_cbranch_scc1 p2_done
    s_cbranch_vccz p2_done
    s_mov_b64 exec, vcc
    s_sleep 2
    s_branch p2
p2_done:
    s_mov_b64 exec, -1
p2join:
    s_cmp_lg_u32 s2, 0
    s_cbranch_scc1 noep
    s_cmp_lg_u32 s52, 0
    s_cbranch_scc1 noep
    v_mov_b32 v10, 19988480
    v_mov_b32 v11, s55
    s_mov_b64 exec, 1
    buffer_store_dword v11, v10, s[4:7], 0 offen sc1
    s_mov_b64 exec, -1
noep:
    s_barrier
    s_lshl_b32 s61, s52, 10
    s_add_u32 s61, s61, 65536
    s_sub_u32 s61, s61, 65536
    s_add_u32 s56, s61, 65536
    s_mov_b32 m0, s56
    s_lshl_b32 s57, s64, 7
    buffer_load_dwordx4 v5, s[4:7], s57 offen sc1 lds
    s_add_u32 s56, s61, 69632
    s_mov_b32 m0, s56
    s_lshl_b32 s57, s65, 7
    buffer_load_dwordx4 v5, s[4:7], s57 offen sc1 lds
    s_add_u32 s56, s61, 73728
    s_mov_b32 m0, s56
    s_lshl_b32 s57, s66, 7
    buffer_load_dwordx4 v5, s[4:7], s57 offen sc1 lds
    s_add_u32 s56, s61, 77824
    s_mov_b32 m0, s56
    s_lshl_b32 s57, s67, 7
    buffer_load_dwordx4 v5, s[4:7], s57 offen sc1 lds
    s_add_u32 s56, s61, 81920
    s_mov_b32 m0, s56
    s_lshl_b32 s57, s68, 7
    buffer_load_dwordx4 v5, s[4:7], s57 offen sc1 lds
    s_add_u32 s56, s61, 86016
    s_mov_b32 m0, s56
    s_lshl_b32 s57, s69, 7
    buffer_load_dwordx4 v5, s[4:7], s57 offen sc1 lds
    s_add_u32 s56, s61, 90112
    s_mov_b32 m0, s56
    s_lshl_b32 s57, s70, 7
    buffer_load_dwordx4 v5, s[4:7], s57 offen sc1 lds
    s_add_u32 s56, s61, 94208
    s_mov_b32 m0, s56
    s_lshl_b32 s57, s71, 7
    buffer_load_dwordx4 v5, s[4:7], s57 offen sc1 lds
    s_add_u32 s56, s61, 98304
    s_mov_b32 m0, s56
    s_lshl_b32 s57, s72, 7
    buffer_load_dwordx4 v5, s[4:7], s57 offen sc1 lds
    s_add_u32 s56, s61, 102400
    s_mov_b32 m0, s56
    s_lshl_b32 s57, s73, 7
    buffer_load_dwordx4 v5, s[4:7], s57 offen sc1 lds
    s_add_u32 s56, s61, 106496
    s_mov_b32 m0, s56
    s_lshl_b32 s57, s74, 7
    buffer_load_dwordx4 v5, s[4:7], s57 offen sc1 lds
    s_add_u32 s56, s61, 110592
    s_mov_b32 m0, s56
    s_lshl_b32 s57, s75, 7
    buffer_load_dwordx4 v5, s[4:7], s57 offen sc1 lds
    s_add_u32 s56, s61, 114688
    s_mov_b32 m0, s56
    s_lshl_b32 s57, s76, 7
    buffer_load_dwordx4 v5, s[4:7], s57 offen sc1 lds
    s_add_u32 s56, s61, 118784
    s_mov_b32 m0, s56
    s_lshl_b32 s57, s77, 7
    buffer_load_dwordx4 v5, s[4:7], s57 offen sc1 lds
    s_add_u32 s56, s61, 122880
    s_mov_b32 m0, s56
    s_lshl_b32 s57, s78, 7
    buffer_load_dwordx4 v5, s[4:7], s57 offen sc1 lds
    s_add_u32 s56, s61, 126976
    s_mov_b32 m0, s56
    s_lshl_b32 s57, s79, 7
    buffer_load_dwordx4 v5, s[4:7], s57 offen sc1 lds
    v_mov_b32 v120, s99
    v_mov_b32 v136, 0
    v_mov_b32 v128, 0
    v_mov_b32 v121, s99
    v_mov_b32 v137, 0
    v_mov_b32 v129, 0
    v_mov_b32 v122, s99
    v_mov_b32 v138, 0
    v_mov_b32 v130, 0
    v_mov_b32 v123, s99
    v_mov_b32 v139, 0
    v_mov_b32 v131, 0
    s_waitcnt vmcnt(12)
    s_barrier
    v_lshrrev_b32 v11, 1, v4
    v_lshlrev_b32 v11, 9, v11
    v_lshl_add_u32 v11, v3, 4, v11
    v_and_b32 v7, 1, v4
    v_lshl_add_u32 v11, v7, 3, v11
    s_mul_i32 s56, s96, 176128
    s_lshl_b32 s57, s46, 10
    s_add_u32 s56, s56, s57
    s_add_u32 s56, s56, 8388608
    v_add_u32 v8, s56, v11
    v_add_u32 v9, 4096, v8
    v_add_u32 v10, 8192, v8
    v_add_u32 v10, s47, v10
    v_min_u32 v15, 7, v2
    v_lshlrev_b32 v15, 6, v15
    s_lshl_b32 s56, s96, 9
    v_add_u32 v15, s56, v15
    ds_read2st64_b32 v[72:73], v16 offset0:0 offset1:1
    ds_read2st64_b32 v[74:75], v16 offset0:2 offset1:3
    ds_read2st64_b32 v[76:77], v17 offset0:0 offset1:1
    ds_read2st64_b32 v[78:79], v17 offset0:2 offset1:3
    s_waitcnt lgkmcnt(0)
    v_mfma_f32_16x16x32_bf16 v[24:27], a[0:3], v[72:75], v[24:27]
    ds_read2st64_b32 v[80:81], v16 offset0:16 offset1:17
    ds_read2st64_b32 v[82:83], v16 offset0:18 offset1:19
    v_mfma_f32_16x16x32_bf16 v[28:31], a[0:3], v[76:79], v[28:31]
    ds_read2st64_b32 v[84:85], v17 offset0:16 offset1:17
    ds_read2st64_b32 v[86:87], v17 offset0:18 offset1:19
    s_add_u32 s56, s61, 0
    s_mov_b32 m0, s56
    s_lshl_b32 s57, s64, 7
    buffer_load_dwordx4 v6, s[4:7], s57 offen sc1 lds
    v_mfma_f32_16x16x32_bf16 v[40:43], a[4:7], v[72:75], v[40:43]
    v_mfma_f32_16x16x32_bf16 v[44:47], a[4:7], v[76:79], v[44:47]
    s_add_u32 s56, s61, 4096
    s_mov_b32 m0, s56
    s_lshl_b32 s57, s65, 7
    buffer_load_dwordx4 v6, s[4:7], s57 offen sc1 lds
    v_mfma_f32_16x16x32_bf16 v[56:59], a[8:11], v[72:75], v[56:59]
    v_mfma_f32_16x16x32_bf16 v[60:63], a[8:11], v[76:79], v[60:63]
    s_add_u32 s56, s61, 8192
    s_mov_b32 m0, s56
    s_lshl_b32 s57, s66, 7
    buffer_load_dwordx4 v6, s[4:7], s57 offen sc1 lds
    s_waitcnt lgkmcnt(0)
    v_mfma_f32_16x16x32_bf16 v[24:27], a[12:15], v[80:83], v[24:27]
    ds_read2st64_b32 v[72:73], v16 offset0:32 offset1:33
    ds_read2st64_b32 v[74:75], v16 offset0:34 offset1:35
    v_mfma_f32_16x16x32_bf16 v[28:31], a[12:15], v[84:87], v[28:31]
    ds_read2st64_b32 v[76:77], v17 offset0:32 offset1:33
    ds_read2st64_b32 v[78:79], v17 offset0:34 offset1:35
    s_add_u32 s56, s61, 12288
    s_mov_b32 m0, s56
    s_lshl_b32 s57, s67, 7
    buffer_load_dwordx4 v6, s[4:7], s57 offen sc1 lds
    v_mfma_f32_16x16x32_bf16 v[40:43], a[16:19], v[80:83], v[40:43]
    v_mfma_f32_16x16x32_bf16 v[44:47], a[16:19], v[84:87], v[44:47]
    s_add_u32 s56, s61, 16384
    s_mov_b32 m0, s56
    s_lshl_b32 s57, s68, 7
    buffer_load_dwordx4 v6, s[4:7], s57 offen sc1 lds
    v_mfma_f32_16x16x32_bf16 v[56:59], a[20:23], v[80:83], v[56:59]
    v_mfma_f32_16x16x32_bf16 v[60:63], a[20:23], v[84:87], v[60:63]
    s_add_u32 s56, s61, 20480
    s_mov_b32 m0, s56
    s_lshl_b32 s57, s69, 7
    buffer_load_dwordx4 v6, s[4:7], s57 offen sc1 lds
    s_waitcnt lgkmcnt(0)
    v_mfma_f32_16x16x32_bf16 v[24:27], a[24:27], v[72:75], v[24:27]
    ds_read2st64_b32 v[80:81], v16 offset0:48 offset1:49
    ds_read2st64_b32 v[82:83], v16 offset0:50 offset1:51
    v_mfma_f32_16x16x32_bf16 v[28:31], a[24:27], v[76:79], v[28:31]
    ds_read2st64_b32 v[84:85], v17 offset0:48 offset1:49
    ds_read2st64_b32 v[86:87], v17 offset0:50 offset1:51
    s_add_u32 s56, s61, 24576
    s_mov_b32 m0, s56
    s_lshl_b32 s57, s70, 7
    buffer_load_dwordx4 v6, s[4:7], s57 offen sc1 lds
    v_mfma_f32_16x16x32_bf16 v[40:43], a[28:31], v[72:75], v[40:43]
    v_mfma_f32_16x16x32_bf16 v[44:47], a[28:31], v[76:79], v[44:47]
    s_add_u32 s56, s61, 28672
    s_mov_b32 m0, s56
    s_lshl_b32 s57, s71, 7
    buffer_load_dwordx4 v6, s[4:7], s57 offen sc1 lds
    v_mfma_f32_16x16x32_bf16 v[56:59], a[32:35], v[72:75], v[56:59]
    v_mfma_f32_16x16x32_bf16 v[60:63], a[32:35], v[76:79], v[60:63]
    s_add_u32 s56, s61, 32768
    s_mov_b32 m0, s56
    s_lshl_b32 s57, s72, 7
    buffer_load_dwordx4 v6, s[4:7], s57 offen sc1 lds
    s_waitcnt vmcnt(17)
    s_barrier
    s_waitcnt lgkmcnt(0)
    v_mfma_f32_16x16x32_bf16 v[24:27], a[36:39], v[80:83], v[24:27]
    ds_read2st64_b32 v[72:73], v16 offset0:64 offset1:65
    ds_read2st64_b32 v[74:75], v16 offset0:66 offset1:67
    v_mfma_f32_16x16x32_bf16 v[28:31], a[36:39], v[84:87], v[28:31]
    ds_read2st64_b32 v[76:77], v17 offset0:64 offset1:65
    ds_read2st64_b32 v[78:79], v17 offset0:66 offset1:67
    s_add_u32 s56, s61, 36864
    s_mov_b32 m0, s56
    s_lshl_b32 s57, s73, 7
    buffer_load_dwordx4 v6, s[4:7], s57 offen sc1 lds
    v_mfma_f32_16x16x32_bf16 v[40:43], a[40:43], v[80:83], v[40:43]
    v_mfma_f32_16x16x32_bf16 v[44:47], a[40:43], v[84:87], v[44:47]
    s_add_u32 s56, s61, 40960
    s_mov_b32 m0, s56
    s_lshl_b32 s57, s74, 7
    buffer_load_dwordx4 v6, s[4:7], s57 offen sc1 lds
    v_mfma_f32_16x16x32_bf16 v[56:59], a[44:47], v[80:83], v[56:59]
    v_mfma_f32_16x16x32_bf16 v[60:63], a[44:47], v[84:87], v[60:63]
    s_add_u32 s56, s61, 45056
    s_mov_b32 m0, s56
    s_lshl_b32 s57, s75, 7
    buffer_load_dwordx4 v6, s[4:7], s57 offen sc1 lds
    s_waitcnt lgkmcnt(0)
    v_mfma_f32_16x16x32_bf16 v[24:27], a[48:51], v[72:75], v[24:27]
    ds_read2st64_b32 v[80:81], v16 offset0:80 offset1:81
    ds_read2st64_b32 v[82:83], v16 offset0:82 offset1:83
    v_mfma_f32_16x16x32_bf16 v[28:31], a[48:51], v[76:79], v[28:31]
    ds_read2st64_b32 v[84:85], v17 offset0:80 offset1:81
    ds_read2st64_b32 v[86:87], v17 offset0:82 offset1:83
    s_add_u32 s56, s61, 49152
    s_mov_b32 m0, s56
    s_lshl_b32 s57, s76, 7
    buffer_load_dwordx4 v6, s[4:7], s57 offen sc1 lds
    v_mfma_f32_16x16x32_bf16 v[40:43], a[52:55], v[72:75], v[40:43]
    v_mfma_f32_16x16x32_bf16 v[44:47], a[52:55], v[76:79], v[44:47]
    s_add_u32 s56, s61, 53248
    s_mov_b32 m0, s56
    s_lshl_b32 s57, s77, 7
    buffer_load_dwordx4 v6, s[4:7], s57 offen sc1 lds
    v_mfma_f32_16x16x32_bf16 v[56:59], a[56:59], v[72:75], v[56:59]
    v_mfma_f32_16x16x32_bf16 v[60:63], a[56:59], v[76:79], v[60:63]
    s_add_u32 s56, s61, 57344
    s_mov_b32 m0, s56
    s_lshl_b32 s57, s78, 7
    buffer_load_dwordx4 v6, s[4:7], s57 offen sc1 lds
    s_waitcnt lgkmcnt(0)
    v_mfma_f32_16x16x32_bf16 v[24:27], a[60:63], v[80:83], v[24:27]
    ds_read2st64_b32 v[72:73], v16 offset0:96 offset1:97
    ds_read2st64_b32 v[74:75], v16 offset0:98 offset1:99
    v_mfma_f32_16x16x32_bf16 v[28:31], a[60:63], v[84:87], v[28:31]
    ds_read2st64_b32 v[76:77], v17 offset0:96 offset1:97
    ds_read2st64_b32 v[78:79], v17 offset0:98 offset1:99
    s_add_u32 s56, s61, 61440
    s_mov_b32 m0, s56
    s_lshl_b32 s57, s79, 7
    buffer_load_dwordx4 v6, s[4:7], s57 offen sc1 lds
    v_mfma_f32_16x16x32_bf16 v[40:43], a[64:67], v[80:83], v[40:43]
    v_mfma_f32_16x16x32_bf16 v[44:47], a[64:67], v[84:87], v[44:47]
    buffer_load_dwordx4 a[192:195], v20, s[4:7], s80 offen sc1
    v_mfma_f32_16x16x32_bf16 v[56:59], a[68:71], v[80:83], v[56:59]
    v_mfma_f32_16x16x32_bf16 v[60:63], a[68:71], v[84:87], v[60:63]
    s_waitcnt lgkmcnt(0)
    v_mfma_f32_16x16x32_bf16 v[24:27], a[72:75], v[72:75], v[24:27]
    ds_read2st64_b32 v[80:81], v16 offset0:112 offset1:113
    ds_read2st64_b32 v[82:83], v16 offset0:114 offset1:115
    v_mfma_f32_16x16x32_bf16 v[28:31], a[72:75], v[76:79], v[28:31]
    ds_read2st64_b32 v[84:85], v17 offset0:112 offset1:113
    ds_read2st64_b32 v[86:87], v17 offset0:114 offset1:115
    v_mfma_f32_16x16x32_bf16 v[40:43], a[76:79], v[72:75], v[40:43]
    v_mfma_f32_16x16x32_bf16 v[44:47], a[76:79], v[76:79], v[44:47]
    buffer_load_dwordx4 a[196:199], v21, s[4:7], s80 offen sc1
    v_mfma_f32_16x16x32_bf16 v[56:59], a[80:83], v[72:75], v[56:59]
    v_mfma_f32_16x16x32_bf16 v[60:63], a[80:83], v[76:79], v[60:63]
    s_waitcnt vmcnt(10)
    s_barrier
    s_waitcnt lgkmcnt(0)
    v_mfma_f32_16x16x32_bf16 v[24:27], a[84:87], v[80:83], v[24:27]
    ds_read2st64_b32 v[72:73], v16 offset0:128 offset1:129
    ds_read2st64_b32 v[74:75], v16 offset0:130 offset1:131
    v_mfma_f32_16x16x32_bf16 v[28:31], a[84:87], v[84:87], v[28:31]
    ds_read2st64_b32 v[76:77], v17 offset0:128 offset1:129
    ds_read2st64_b32 v[78:79], v17 offset0:130 offset1:131
    v_mfma_f32_16x16x32_bf16 v[40:43], a[88:91], v[80:83], v[40:43]
    ds_read2st64_b32 v[88:89], v141 offset0:0 offset1:1
    ds_read2st64_b32 v[90:91], v141 offset0:2 offset1:3
    v_mfma_f32_16x16x32_bf16 v[44:47], a[88:91], v[84:87], v[44:47]
    ds_read2st64_b32 v[92:93], v141 offset0:16 offset1:17
    ds_read2st64_b32 v[94:95], v141 offset0:18 offset1:19
    buffer_load_dwordx4 a[200:203], v20, s[4:7], s81 offen sc1
    v_mfma_f32_16x16x32_bf16 v[56:59], a[92:95], v[80:83], v[56:59]
    v_mfma_f32_16x16x32_bf16 v[60:63], a[92:95], v[84:87], v[60:63]
    s_waitcnt lgkmcnt(0)
    v_mfma_f32_16x16x32_bf16 v[128:131], v[92:95], v[92:95], v[128:131]
    ds_read2st64_b32 v[80:81], v16 offset0:144 offset1:145
    ds_read2st64_b32 v[82:83], v16 offset0:146 offset1:147
    v_mfma_f32_16x16x32_bf16 v[136:139], v[120:123], v[92:95], v[136:139]
    ds_read2st64_b32 v[84:85], v17 offset0:144 offset1:145
    ds_read2st64_b32 v[86:87], v17 offset0:146 offset1:147
    v_mfma_f32_16x16x32_bf16 v[128:131], v[88:91], v[88:91], v[128:131]
    ds_read2st64_b32 v[96:97], v141 offset0:32 offset1:33
    ds_read2st64_b32 v[98:99], v141 offset0:34 offset1:35
    v_mfma_f32_16x16x32_bf16 v[136:139], v[120:123], v[88:91], v[136:139]
    ds_read2st64_b32 v[100:101], v141 offset0:48 offset1:49
    ds_read2st64_b32 v[102:103], v141 offset0:50 offset1:51
    buffer_load_dwordx4 a[204:207], v21, s[4:7], s81 offen sc1
    v_mfma_f32_16x16x32_bf16 v[24:27], a[96:99], v[72:75], v[24:27]
    v_mfma_f32_16x16x32_bf16 v[28:31], a[96:99], v[76:79], v[28:31]
    v_mfma_f32_16x16x32_bf16 v[40:43], a[100:103], v[72:75], v[40:43]
    v_mfma_f32_16x16x32_bf16 v[44:47], a[100:103], v[76:79], v[44:47]
    buffer_load_dwordx4 a[208:211], v20, s[4:7], s82 offen sc1
    v_mfma_f32_16x16x32_bf16 v[56:59], a[104:107], v[72:75], v[56:59]
    v_mfma_f32_16x16x32_bf16 v[60:63], a[104:107], v[76:79], v[60:63]
    s_waitcnt lgkmcnt(0)
    v_mfma_f32_16x16x32_bf16 v[128:131], v[100:103], v[100:103], v[128:131]
    ds_read2st64_b32 v[72:73], v16 offset0:160 offset1:161
    ds_read2st64_b32 v[74:75], v16 offset0:162 offset1:163
    v_mfma_f32_16x16x32_bf16 v[136:139], v[120:123], v[100:103], v[136:139]
    ds_read2st64_b32 v[76:77], v17 offset0:160 offset1:161
    ds_read2st64_b32 v[78:79], v17 offset0:162 offset1:163
    v_mfma_f32_16x16x32_bf16 v[128:131], v[96:99], v[96:99], v[128:131]
    ds_read2st64_b32 v[88:89], v141 offset0:64 offset1:65
    ds_read2st64_b32 v[90:91], v141 offset0:66 offset1:67
    v_mfma_f32_16x16x32_bf16 v[136:139], v[120:123], v[96:99], v[136:139]
    ds_read2st64_b32 v[92:93], v141 offset0:80 offset1:81
    ds_read2st64_b32 v[94:95], v141 offset0:82 offset1:83
    buffer_load_dwordx4 a[212:215], v21, s[4:7], s82 offen sc1
    v_mfma_f32_16x16x32_bf16 v[24:27], a[108:111], v[80:83], v[24:27]
    v_mfma_f32_16x16x32_bf16 v[28:31], a[108:111], v[84:87], v[28:31]
    v_mfma_f32_16x16x32_bf16 v[40:43], a[112:115], v[80:83], v[40:43]
    v_mfma_f32_16x16x32_bf16 v[44:47], a[112:115], v[84:87], v[44:47]
    buffer_load_dwordx4 a[216:219], v20, s[4:7], s83 offen sc1
    v_mfma_f32_16x16x32_bf16 v[56:59], a[116:119], v[80:83], v[56:59]
    v_mfma_f32_16x16x32_bf16 v[60:63], a[116:119], v[84:87], v[60:63]
    s_waitcnt lgkmcnt(0)
    v_mfma_f32_16x16x32_bf16 v[128:131], v[92:95], v[92:95], v[128:131]
    ds_read2st64_b32 v[80:81], v16 offset0:176 offset1:177
    ds_read2st64_b32 v[82:83], v16 offset0:178 offset1:179
    v_mfma_f32_16x16x32_bf16 v[136:139], v[120:123], v[92:95], v[136:139]
    ds_read2st64_b32 v[84:85], v17 offset0:176 offset1:177
    ds_read2st64_b32 v[86:87], v17 offset0:178 offset1:179
    v_mfma_f32_16x16x32_bf16 v[128:131], v[88:91], v[88:91], v[128:131]
    ds_read2st64_b32 v[96:97], v141 offset0:96 offset1:97
    ds_read2st64_b32 v[98:99], v141 offset0:98 offset1:99
    v_mfma_f32_16x16x32_bf16 v[136:139], v[120:123], v[88:91], v[136:139]
    ds_read2st64_b32 v[100:101], v141 offset0:112 offset1:113
    ds_read2st64_b32 v[102:103], v141 offset0:114 offset1:115
    buffer_load_dwordx4 a[220:223], v21, s[4:7], s83 offen sc1
    v_mfma_f32_16x16x32_bf16 v[24:27], a[120:123], v[72:75], v[24:27]
    v_mfma_f32_16x16x32_bf16 v[28:31], a[120:123], v[76:79], v[28:31]
    v_mfma_f32_16x16x32_bf16 v[40:43], a[124:127], v[72:75], v[40:43]
    v_mfma_f32_16x16x32_bf16 v[44:47], a[124:127], v[76:79], v[44:47]
    buffer_load_dwordx4 a[224:227], v20, s[4:7], s84 offen sc1
    v_mfma_f32_16x16x32_bf16 v[56:59], a[128:131], v[72:75], v[56:59]
    v_mfma_f32_16x16x32_bf16 v[60:63], a[128:131], v[76:79], v[60:63]
    s_waitcnt vmcnt(9)
    s_barrier
    s_waitcnt lgkmcnt(0)
    v_mfma_f32_16x16x32_bf16 v[128:131], v[100:103], v[100:103], v[128:131]
    ds_read2st64_b32 v[72:73], v16 offset0:192 offset1:193
    ds_read2st64_b32 v[74:75], v16 offset0:194 offset1:195
    v_mfma_f32_16x16x32_bf16 v[136:139], v[120:123], v[100:103], v[136:139]
    ds_read2st64_b32 v[76:77], v17 offset0:192 offset1:193
    ds_read2st64_b32 v[78:79], v17 offset0:194 offset1:195
    v_mfma_f32_16x16x32_bf16 v[128:131], v[96:99], v[96:99], v[128:131]
    ds_read2st64_b32 v[88:89], v141 offset0:128 offset1:129
    ds_read2st64_b32 v[90:91], v141 offset0:130 offset1:131
    v_mfma_f32_16x16x32_bf16 v[136:139], v[120:123], v[96:99], v[136:139]
    ds_read2st64_b32 v[92:93], v141 offset0:144 offset1:145
    ds_read2st64_b32 v[94:95], v141 offset0:146 offset1:147
    buffer_load_dwordx4 a[228:231], v21, s[4:7], s84 offen sc1
    v_mfma_f32_16x16x32_bf16 v[24:27], a[132:135], v[80:83], v[24:27]
    v_mfma_f32_16x16x32_bf16 v[28:31], a[132:135], v[84:87], v[28:31]
    v_mfma_f32_16x16x32_bf16 v[40:43], a[136:139], v[80:83], v[40:43]
    v_mfma_f32_16x16x32_bf16 v[44:47], a[136:139], v[84:87], v[44:47]
    buffer_load_dwordx4 a[232:235], v20, s[4:7], s85 offen sc1
    v_mfma_f32_16x16x32_bf16 v[56:59], a[140:143], v[80:83], v[56:59]
    v_mfma_f32_16x16x32_bf16 v[60:63], a[140:143], v[84:87], v[60:63]
    s_waitcnt lgkmcnt(0)
    v_mfma_f32_16x16x32_bf16 v[128:131], v[92:95], v[92:95], v[128:131]
    ds_read2st64_b32 v[80:81], v16 offset0:208 offset1:209
    ds_read2st64_b32 v[82:83], v16 offset0:210 offset1:211
    v_mfma_f32_16x16x32_bf16 v[136:139], v[120:123], v[92:95], v[136:139]
    ds_read2st64_b32 v[84:85], v17 offset0:208 offset1:209
    ds_read2st64_b32 v[86:87], v17 offset0:210 offset1:211
    v_mfma_f32_16x16x32_bf16 v[128:131], v[88:91], v[88:91], v[128:131]
    ds_read2st64_b32 v[96:97], v141 offset0:160 offset1:161
    ds_read2st64_b32 v[98:99], v141 offset0:162 offset1:163
    v_mfma_f32_16x16x32_bf16 v[136:139], v[120:123], v[88:91], v[136:139]
    ds_read2st64_b32 v[100:101], v141 offset0:176 offset1:177
    ds_read2st64_b32 v[102:103], v141 offset0:178 offset1:179
    buffer_load_dwordx4 a[236:239], v21, s[4:7], s85 offen sc1
    v_mfma_f32_16x16x32_bf16 v[24:27], a[144:147], v[72:75], v[24:27]
    v_mfma_f32_16x16x32_bf16 v[28:31], a[144:147], v[76:79], v[28:31]
    v_mfma_f32_16x16x32_bf16 v[40:43], a[148:151], v[72:75], v[40:43]
    v_mfma_f32_16x16x32_bf16 v[44:47], a[148:151], v[76:79], v[44:47]
    buffer_load_dwordx4 a[240:243], v20, s[4:7], s86 offen sc1
    v_mfma_f32_16x16x32_bf16 v[56:59], a[152:155], v[72:75], v[56:59]
    v_mfma_f32_16x16x32_bf16 v[60:63], a[152:155], v[76:79], v[60:63]
    s_waitcnt lgkmcnt(0)
    v_mfma_f32_16x16x32_bf16 v[128:131], v[100:103], v[100:103], v[128:131]
    ds_read2st64_b32 v[72:73], v16 offset0:224 offset1:225
    ds_read2st64_b32 v[74:75], v16 offset0:226 offset1:227
    v_mfma_f32_16x16x32_bf16 v[136:139], v[120:123], v[100:103], v[136:139]
    ds_read2st64_b32 v[76:77], v17 offset0:224 offset1:225
    ds_read2st64_b32 v[78:79], v17 offset0:226 offset1:227
    v_mfma_f32_16x16x32_bf16 v[128:131], v[96:99], v[96:99], v[128:131]
    ds_read2st64_b32 v[88:89], v141 offset0:192 offset1:193
    ds_read2st64_b32 v[90:91], v141 offset0:194 offset1:195
    v_mfma_f32_16x16x32_bf16 v[136:139], v[120:123], v[96:99], v[136:139]
    ds_read2st64_b32 v[92:93], v141 offset0:208 offset1:209
    ds_read2st64_b32 v[94:95], v141 offset0:210 offset1:211
    buffer_load_dwordx4 a[244:247], v21, s[4:7], s86 offen sc1
    v_mfma_f32_16x16x32_bf16 v[24:27], a[156:159], v[80:83], v[24:27]
    v_mfma_f32_16x16x32_bf16 v[28:31], a[156:159], v[84:87], v[28:31]
    v_mfma_f32_16x16x32_bf16 v[40:43], a[160:163], v[80:83], v[40:43]
    v_mfma_f32_16x16x32_bf16 v[44:47], a[160:163], v[84:87], v[44:47]
    buffer_load_dwordx4 a[248:251], v20, s[4:7], s87 offen sc1
    v_mfma_f32_16x16x32_bf16 v[56:59], a[164:167], v[80:83], v[56:59]
    v_mfma_f32_16x16x32_bf16 v[60:63], a[164:167], v[84:87], v[60:63]
    s_waitcnt lgkmcnt(0)
    v_mfma_f32_16x16x32_bf16 v[128:131], v[92:95], v[92:95], v[128:131]
    ds_read2st64_b32 v[80:81], v16 offset0:240 offset1:241
    ds_read2st64_b32 v[82:83], v16 offset0:242 offset1:243
    v_mfma_f32_16x16x32_bf16 v[136:139], v[120:123], v[92:95], v[136:139]
    ds_read2st64_b32 v[84:85], v17 offset0:240 offset1:241
    ds_read2st64_b32 v[86:87], v17 offset0:242 offset1:243
    v_mfma_f32_16x16x32_bf16 v[128:131], v[88:91], v[88:91], v[128:131]
    ds_read2st64_b32 v[96:97], v141 offset0:224 offset1:225
    ds_read2st64_b32 v[98:99], v141 offset0:226 offset1:227
    v_mfma_f32_16x16x32_bf16 v[136:139], v[120:123], v[88:91], v[136:139]
    ds_read2st64_b32 v[100:101], v141 offset0:240 offset1:241
    ds_read2st64_b32 v[102:103], v141 offset0:242 offset1:243
    buffer_load_dwordx4 a[252:255], v21, s[4:7], s87 offen sc1
    v_mfma_f32_16x16x32_bf16 v[24:27], a[168:171], v[72:75], v[24:27]
    v_mfma_f32_16x16x32_bf16 v[28:31], a[168:171], v[76:79], v[28:31]
    v_mfma_f32_16x16x32_bf16 v[40:43], a[172:175], v[72:75], v[40:43]
    v_mfma_f32_16x16x32_bf16 v[44:47], a[172:175], v[76:79], v[44:47]
    buffer_load_dwordx4 v[252:255], v20, s[4:7], s88 offen sc1
    v_mfma_f32_16x16x32_bf16 v[56:59], a[176:179], v[72:75], v[56:59]
    v_mfma_f32_16x16x32_bf16 v[60:63], a[176:179], v[76:79], v[60:63]
    s_waitcnt lgkmcnt(0)
    v_mfma_f32_16x16x32_bf16 v[128:131], v[100:103], v[100:103], v[128:131]
    v_mfma_f32_16x16x32_bf16 v[136:139], v[120:123], v[100:103], v[136:139]
    v_mfma_f32_16x16x32_bf16 v[128:131], v[96:99], v[96:99], v[128:131]
    v_mfma_f32_16x16x32_bf16 v[136:139], v[120:123], v[96:99], v[136:139]
    buffer_load_dwordx4 v[248:251], v21, s[4:7], s88 offen sc1
    v_mfma_f32_16x16x32_bf16 v[24:27], a[180:183], v[80:83], v[24:27]
    v_mfma_f32_16x16x32_bf16 v[28:31], a[180:183], v[84:87], v[28:31]
    v_mfma_f32_16x16x32_bf16 v[40:43], a[184:187], v[80:83], v[40:43]
    v_mfma_f32_16x16x32_bf16 v[44:47], a[184:187], v[84:87], v[44:47]
    buffer_load_dwordx4 v[244:247], v20, s[4:7], s89 offen sc1
    v_mfma_f32_16x16x32_bf16 v[56:59], a[188:191], v[80:83], v[56:59]
    v_mfma_f32_16x16x32_bf16 v[60:63], a[188:191], v[84:87], v[60:63]
    v_and_b32 v124, 3, v3
    v_lshrrev_b32 v125, 2, v3
    v_cmp_eq_u32 s[62:63], v125, v4
    v_lshlrev_b32 v90, 3, v3
    s_lshl_b32 s56, s52, 7
    s_add_u32 s56, s56, 138880
    v_add_u32 v91, s56, v90
    v_add_u32 v90, 138880, v90
    v_cmp_eq_u32 vcc, 1, v124
    s_nop 1
    v_cndmask_b32 v128, v128, v129, vcc
    v_cmp_eq_u32 vcc, 2, v124
    s_nop 1
    v_cndmask_b32 v128, v128, v130, vcc
    v_cmp_eq_u32 vcc, 3, v124
    s_nop 1
    v_cndmask_b32 v128, v128, v131, vcc
    v_mul_f32 v89, 0x3b000000, v136
    v_mul_f32 v88, 0x3b000000, v128
    v_fma_f32 v88, -v89, v89, v88
    v_max_f32 v88, 0, v88
    v_cvt_pk_bf16_f32 v88, v88, v88
    v_lshlrev_b32 v88, 16, v88
    v_cvt_pk_bf16_f32 v89, v89, v89
    v_lshlrev_b32 v89, 16, v89
    v_add_f32 v88, 0x3727c5ac, v88
    v_cvt_pk_bf16_f32 v88, v88, v88
    v_lshlrev_b32 v88, 16, v88
    v_sqrt_f32 v88, v88
    s_nop 0
    v_cvt_pk_bf16_f32 v88, v88, v88
    v_lshlrev_b32 v88, 16, v88
    v_rcp_f32 v88, v88
    s_nop 0
    v_sub_f32 v89, v89, v140
    v_mul_f32 v89, v89, v88
    s_mov_b64 exec, s[62:63]
    ds_write_b64 v91, v[88:89]
    s_mov_b64 exec, -1
    ds_read_b128 v[104:107], v14 offset:0
    ds_read_b128 v[108:111], v14 offset:64
    ds_read_b128 v[112:115], v14 offset:128
    ds_read_b128 v[116:119], v14 offset:192
    ds_read_b128 v[120:123], v14 offset:256
    ds_read_b128 v[124:127], v14 offset:320
    s_mov_b32 s59, 88064
    s_waitcnt lgkmcnt(0)
    s_barrier
    ds_read_b64 v[128:129], v90 offset:0
    ds_read_b64 v[130:131], v90 offset:128
    ds_read_b64 v[132:133], v90 offset:256
    ds_read_b64 v[134:135], v90 offset:384
    s_waitcnt lgkmcnt(0)
    v_pk_fma_f32 v[72:73], v[116:117], v[128:129], v[104:105] op_sel:[0,1,0] op_sel_hi:[1,1,1] neg_lo:[0,1,0] neg_hi:[0,1,0]
    v_pk_fma_f32 v[76:77], v[116:117], v[130:131], v[104:105] op_sel:[0,1,0] op_sel_hi:[1,1,1] neg_lo:[0,1,0] neg_hi:[0,1,0]
    v_pk_fma_f32 v[74:75], v[118:119], v[128:129], v[106:107] op_sel:[0,1,0] op_sel_hi:[1,1,1] neg_lo:[0,1,0] neg_hi:[0,1,0]
    v_pk_fma_f32 v[78:79], v[118:119], v[130:131], v[106:107] op_sel:[0,1,0] op_sel_hi:[1,1,1] neg_lo:[0,1,0] neg_hi:[0,1,0]
    v_pk_fma_f32 v[24:25], v[24:25], v[128:129], v[72:73] op_sel_hi:[1,0,1]
    v_pk_fma_f32 v[28:29], v[28:29], v[130:131], v[76:77] op_sel_hi:[1,0,1]
    v_pk_fma_f32 v[26:27], v[26:27], v[128:129], v[74:75] op_sel_hi:[1,0,1]
    v_pk_fma_f32 v[30:31], v[30:31], v[130:131], v[78:79] op_sel_hi:[1,0,1]
    v_max_f32 v24, 0, v24
    v_max_f32 v28, 0, v28
    v_max_f32 v25, 0, v25
    v_max_f32 v29, 0, v29
    v_max_f32 v26, 0, v26
    v_max_f32 v30, 0, v30
    v_max_f32 v27, 0, v27
    v_max_f32 v31, 0, v31
    v_pk_mul_f32 v[24:25], v[24:25], v[24:25]
    v_pk_mul_f32 v[28:29], v[28:29], v[28:29]
    v_pk_mul_f32 v[26:27], v[26:27], v[26:27]
    v_pk_mul_f32 v[30:31], v[30:31], v[30:31]
    v_cvt_pk_bf16_f32 v24, v24, v25
    v_cvt_pk_bf16_f32 v28, v28, v29
    v_cvt_pk_bf16_f32 v25, v26, v27
    v_cvt_pk_bf16_f32 v29, v30, v31
    buffer_store_dwordx2 v[24:25], v8, s[4:7], 0 offen offset:0 sc1
    buffer_store_dwordx2 v[28:29], v8, s[4:7], 0 offen offset:256 sc1
    v_pk_fma_f32 v[72:73], v[120:121], v[128:129], v[108:109] op_sel:[0,1,0] op_sel_hi:[1,1,1] neg_lo:[0,1,0] neg_hi:[0,1,0]
    v_pk_fma_f32 v[76:77], v[120:121], v[130:131], v[108:109] op_sel:[0,1,0] op_sel_hi:[1,1,1] neg_lo:[0,1,0] neg_hi:[0,1,0]
    v_pk_fma_f32 v[74:75], v[122:123], v[128:129], v[110:111] op_sel:[0,1,0] op_sel_hi:[1,1,1] neg_lo:[0,1,0] neg_hi:[0,1,0]
    v_pk_fma_f32 v[78:79], v[122:123], v[130:131], v[110:111] op_sel:[0,1,0] op_sel_hi:[1,1,1] neg_lo:[0,1,0] neg_hi:[0,1,0]
    v_pk_fma_f32 v[40:41], v[40:41], v[128:129], v[72:73] op_sel_hi:[1,0,1]
    v_pk_fma_f32 v[44:45], v[44:45], v[130:131], v[76:77] op_sel_hi:[1,0,1]
    v_pk_fma_f32 v[42:43], v[42:43], v[128:129], v[74:75] op_sel_hi:[1,0,1]
    v_pk_fma_f32 v[46:47], v[46:47], v[130:131], v[78:79] op_sel_hi:[1,0,1]
    v_max_f32 v40, 0, v40
    v_max_f32 v44, 0, v44
    v_max_f32 v41, 0, v41
    v_max_f32 v45, 0, v45
    v_max_f32 v42, 0, v42
    v_max_f32 v46, 0, v46
    v_max_f32 v43, 0, v43
    v_max_f32 v47, 0, v47
    v_pk_mul_f32 v[40:41], v[40:41], v[40:41]
    v_pk_mul_f32 v[44:45], v[44:45], v[44:45]
    v_pk_mul_f32 v[42:43], v[42:43], v[42:43]
    v_pk_mul_f32 v[46:47], v[46:47], v[46:47]
    v_cvt_pk_bf16_f32 v40, v40, v41
    v_cvt_pk_bf16_f32 v44, v44, v45
    v_cvt_pk_bf16_f32 v41, v42, v43
    v_cvt_pk_bf16_f32 v45, v46, v47
    buffer_store_dwordx2 v[40:41], v9, s[4:7], 0 offen offset:0 sc1
    buffer_store_dwordx2 v[44:45], v9, s[4:7], 0 offen offset:256 sc1
    v_pk_fma_f32 v[72:73], v[124:125], v[128:129], v[112:113] op_sel:[0,1,0] op_sel_hi:[1,1,1] neg_lo:[0,1,0] neg_hi:[0,1,0]
    v_pk_fma_f32 v[76:77], v[124:125], v[130:131], v[112:113] op_sel:[0,1,0] op_sel_hi:[1,1,1] neg_lo:[0,1,0] neg_hi:[0,1,0]
    v_pk_fma_f32 v[74:75], v[126:127], v[128:129], v[114:115] op_sel:[0,1,0] op_sel_hi:[1,1,1] neg_lo:[0,1,0] neg_hi:[0,1,0]
    v_pk_fma_f32 v[78:79], v[126:127], v[130:131], v[114:115] op_sel:[0,1,0] op_sel_hi:[1,1,1] neg_lo:[0,1,0] neg_hi:[0,1,0]
    v_pk_fma_f32 v[56:57], v[56:57], v[128:129], v[72:73] op_sel_hi:[1,0,1]
    v_pk_fma_f32 v[60:61], v[60:61], v[130:131], v[76:77] op_sel_hi:[1,0,1]
    v_pk_fma_f32 v[58:59], v[58:59], v[128:129], v[74:75] op_sel_hi:[1,0,1]
    v_pk_fma_f32 v[62:63], v[62:63], v[130:131], v[78:79] op_sel_hi:[1,0,1]
    v_max_f32 v56, 0, v56
    v_max_f32 v60, 0, v60
    v_max_f32 v57, 0, v57
    v_max_f32 v61, 0, v61
    v_max_f32 v58, 0, v58
    v_max_f32 v62, 0, v62
    v_max_f32 v59, 0, v59
    v_max_f32 v63, 0, v63
    v_pk_mul_f32 v[56:57], v[56:57], v[56:57]
    v_pk_mul_f32 v[60:61], v[60:61], v[60:61]
    v_pk_mul_f32 v[58:59], v[58:59], v[58:59]
    v_pk_mul_f32 v[62:63], v[62:63], v[62:63]
    v_cvt_pk_bf16_f32 v56, v56, v57
    v_cvt_pk_bf16_f32 v60, v60, v61
    v_cvt_pk_bf16_f32 v57, v58, v59
    v_cvt_pk_bf16_f32 v61, v62, v63
    buffer_store_dwordx2 v[56:57], v10, s[4:7], 0 offen offset:0 sc1
    buffer_store_dwordx2 v[60:61], v10, s[4:7], 0 offen offset:256 sc1
    ds_read2st64_b32 v[72:73], v18 offset0:0 offset1:1
    ds_read2st64_b32 v[74:75], v18 offset0:2 offset1:3
    ds_read2st64_b32 v[76:77], v19 offset0:0 offset1:1
    ds_read2st64_b32 v[78:79], v19 offset0:2 offset1:3
    s_waitcnt lgkmcnt(0)
    v_mfma_f32_16x16x32_bf16 v[32:35], a[0:3], v[72:75], v[32:35]
    ds_read2st64_b32 v[80:81], v18 offset0:16 offset1:17
    ds_read2st64_b32 v[82:83], v18 offset0:18 offset1:19
    v_mfma_f32_16x16x32_bf16 v[36:39], a[0:3], v[76:79], v[36:39]
    ds_read2st64_b32 v[84:85], v19 offset0:16 offset1:17
    ds_read2st64_b32 v[86:87], v19 offset0:18 offset1:19
    v_mfma_f32_16x16x32_bf16 v[48:51], a[4:7], v[72:75], v[48:51]
    v_mfma_f32_16x16x32_bf16 v[52:55], a[4:7], v[76:79], v[52:55]
    buffer_load_dwordx4 v[240:243], v21, s[4:7], s89 offen sc1
    v_mfma_f32_16x16x32_bf16 v[64:67], a[8:11], v[72:75], v[64:67]
    v_mfma_f32_16x16x32_bf16 v[68:71], a[8:11], v[76:79], v[68:71]
    s_waitcnt lgkmcnt(0)
    v_mfma_f32_16x16x32_bf16 v[32:35], a[12:15], v[80:83], v[32:35]
    ds_read2st64_b32 v[72:73], v18 offset0:32 offset1:33
    ds_read2st64_b32 v[74:75], v18 offset0:34 offset1:35
    v_mfma_f32_16x16x32_bf16 v[36:39], a[12:15], v[84:87], v[36:39]
    ds_read2st64_b32 v[76:77], v19 offset0:32 offset1:33
    ds_read2st64_b32 v[78:79], v19 offset0:34 offset1:35
    v_mfma_f32_16x16x32_bf16 v[48:51], a[16:19], v[80:83], v[48:51]
    v_mfma_f32_16x16x32_bf16 v[52:55], a[16:19], v[84:87], v[52:55]
    buffer_load_dwordx4 v[236:239], v20, s[4:7], s90 offen sc1
    v_mfma_f32_16x16x32_bf16 v[64:67], a[20:23], v[80:83], v[64:67]
    v_mfma_f32_16x16x32_bf16 v[68:71], a[20:23], v[84:87], v[68:71]
    s_waitcnt lgkmcnt(0)
    v_mfma_f32_16x16x32_bf16 v[32:35], a[24:27], v[72:75], v[32:35]
    ds_read2st64_b32 v[80:81], v18 offset0:48 offset1:49
    ds_read2st64_b32 v[82:83], v18 offset0:50 offset1:51
    v_mfma_f32_16x16x32_bf16 v[36:39], a[24:27], v[76:79], v[36:39]
    ds_read2st64_b32 v[84:85], v19 offset0:48 offset1:49
    ds_read2st64_b32 v[86:87], v19 offset0:50 offset1:51
    v_mfma_f32_16x16x32_bf16 v[48:51], a[28:31], v[72:75], v[48:51]
    v_mfma_f32_16x16x32_bf16 v[52:55], a[28:31], v[76:79], v[52:55]
    buffer_load_dwordx4 v[232:235], v21, s[4:7], s90 offen sc1
    v_mfma_f32_16x16x32_bf16 v[64:67], a[32:35], v[72:75], v[64:67]
    v_mfma_f32_16x16x32_bf16 v[68:71], a[32:35], v[76:79], v[68:71]
    s_waitcnt lgkmcnt(0)
    v_mfma_f32_16x16x32_bf16 v[32:35], a[36:39], v[80:83], v[32:35]
    ds_read2st64_b32 v[72:73], v18 offset0:64 offset1:65
    ds_read2st64_b32 v[74:75], v18 offset0:66 offset1:67
    v_mfma_f32_16x16x32_bf16 v[36:39], a[36:39], v[84:87], v[36:39]
    ds_read2st64_b32 v[76:77], v19 offset0:64 offset1:65
    ds_read2st64_b32 v[78:79], v19 offset0:66 offset1:67
    v_mfma_f32_16x16x32_bf16 v[48:51], a[40:43], v[80:83], v[48:51]
    v_mfma_f32_16x16x32_bf16 v[52:55], a[40:43], v[84:87], v[52:55]
    buffer_load_dwordx4 v[228:231], v20, s[4:7], s91 offen sc1
    v_mfma_f32_16x16x32_bf16 v[64:67], a[44:47], v[80:83], v[64:67]
    v_mfma_f32_16x16x32_bf16 v[68:71], a[44:47], v[84:87], v[68:71]
    s_waitcnt lgkmcnt(0)
    v_mfma_f32_16x16x32_bf16 v[32:35], a[48:51], v[72:75], v[32:35]
    ds_read2st64_b32 v[80:81], v18 offset0:80 offset1:81
    ds_read2st64_b32 v[82:83], v18 offset0:82 offset1:83
    v_mfma_f32_16x16x32_bf16 v[36:39], a[48:51], v[76:79], v[36:39]
    ds_read2st64_b32 v[84:85], v19 offset0:80 offset1:81
    ds_read2st64_b32 v[86:87], v19 offset0:82 offset1:83
    v_mfma_f32_16x16x32_bf16 v[48:51], a[52:55], v[72:75], v[48:51]
    v_mfma_f32_16x16x32_bf16 v[52:55], a[52:55], v[76:79], v[52:55]
    buffer_load_dwordx4 v[224:227], v21, s[4:7], s91 offen sc1
    v_mfma_f32_16x16x32_bf16 v[64:67], a[56:59], v[72:75], v[64:67]
    v_mfma_f32_16x16x32_bf16 v[68:71], a[56:59], v[76:79], v[68:71]
    s_waitcnt vmcnt(5)
    s_barrier
    s_cmp_lg_u32 s52, 0
    s_cbranch_scc1 L_fl_4
    s_lshl_b32 s56, s96, 3
    s_add_u32 s56, s56, s97
    s_lshl_b32 s56, s56, 6
    s_add_u32 s56, s56, 19972096
    v_mov_b32 v92, s56
    v_mov_b32 v93, s55
    s_mov_b64 exec, 1
    buffer_store_dword v93, v92, s[4:7], 0 offen sc1
    s_mov_b64 exec, -1
L_fl_4:
    s_waitcnt lgkmcnt(0)
    v_mfma_f32_16x16x32_bf16 v[32:35], a[60:63], v[80:83], v[32:35]
    ds_read2st64_b32 v[72:73], v18 offset0:96 offset1:97
    ds_read2st64_b32 v[74:75], v18 offset0:98 offset1:99
    v_mfma_f32_16x16x32_bf16 v[36:39], a[60:63], v[84:87], v[36:39]
    ds_read2st64_b32 v[76:77], v19 offset0:96 offset1:97
    ds_read2st64_b32 v[78:79], v19 offset0:98 offset1:99
    v_mfma_f32_16x16x32_bf16 v[48:51], a[64:67], v[80:83], v[48:51]
    v_mfma_f32_16x16x32_bf16 v[52:55], a[64:67], v[84:87], v[52:55]
    buffer_load_dwordx4 v[220:223], v20, s[4:7], s92 offen sc1
    v_mfma_f32_16x16x32_bf16 v[64:67], a[68:71], v[80:83], v[64:67]
    v_mfma_f32_16x16x32_bf16 v[68:71], a[68:71], v[84:87], v[68:71]
    s_waitcnt lgkmcnt(0)
    v_mfma_f32_16x16x32_bf16 v[32:35], a[72:75], v[72:75], v[32:35]
    ds_read2st64_b32 v[80:81], v18 offset0:112 offset1:113
    ds_read2st64_b32 v[82:83], v18 offset0:114 offset1:115
    v_mfma_f32_16x16x32_bf16 v[36:39], a[72:75], v[76:79], v[36:39]
    ds_read2st64_b32 v[84:85], v19 offset0:112 offset1:113
    ds_read2st64_b32 v[86:87], v19 offset0:114 offset1:115
    v_mfma_f32_16x16x32_bf16 v[48:51], a[76:79], v[72:75], v[48:51]
    v_mfma_f32_16x16x32_bf16 v[52:55], a[76:79], v[76:79], v[52:55]
    buffer_load_dwordx4 v[216:219], v21, s[4:7], s92 offen sc1
    v_mfma_f32_16x16x32_bf16 v[64:67], a[80:83], v[72:75], v[64:67]
    v_mfma_f32_16x16x32_bf16 v[68:71], a[80:83], v[76:79], v[68:71]
    s_waitcnt lgkmcnt(0)
    v_mfma_f32_16x16x32_bf16 v[32:35], a[84:87], v[80:83], v[32:35]
    ds_read2st64_b32 v[72:73], v18 offset0:128 offset1:129
    ds_read2st64_b32 v[74:75], v18 offset0:130 offset1:131
    v_mfma_f32_16x16x32_bf16 v[36:39], a[84:87], v[84:87], v[36:39]
    ds_read2st64_b32 v[76:77], v19 offset0:128 offset1:129
    ds_read2st64_b32 v[78:79], v19 offset0:130 offset1:131
    v_mfma_f32_16x16x32_bf16 v[48:51], a[88:91], v[80:83], v[48:51]
    v_mfma_f32_16x16x32_bf16 v[52:55], a[88:91], v[84:87], v[52:55]
    buffer_load_dwordx4 v[212:215], v20, s[4:7], s93 offen sc1
    v_mfma_f32_16x16x32_bf16 v[64:67], a[92:95], v[80:83], v[64:67]
    v_mfma_f32_16x16x32_bf16 v[68:71], a[92:95], v[84:87], v[68:71]
    s_waitcnt lgkmcnt(0)
    v_mfma_f32_16x16x32_bf16 v[32:35], a[96:99], v[72:75], v[32:35]
    ds_read2st64_b32 v[80:81], v18 offset0:144 offset1:145
    ds_read2st64_b32 v[82:83], v18 offset0:146 offset1:147
    v_mfma_f32_16x16x32_bf16 v[36:39], a[96:99], v[76:79], v[36:39]
    ds_read2st64_b32 v[84:85], v19 offset0:144 offset1:145
    ds_read2st64_b32 v[86:87], v19 offset0:146 offset1:147
    v_mfma_f32_16x16x32_bf16 v[48:51], a[100:103], v[72:75], v[48:51]
    v_mfma_f32_16x16x32_bf16 v[52:55], a[100:103], v[76:79], v[52:55]
    buffer_load_dwordx4 v[208:211], v21, s[4:7], s93 offen sc1
    v_mfma_f32_16x16x32_bf16 v[64:67], a[104:107], v[72:75], v[64:67]
    v_mfma_f32_16x16x32_bf16 v[68:71], a[104:107], v[76:79], v[68:71]
    s_waitcnt lgkmcnt(0)
    v_mfma_f32_16x16x32_bf16 v[32:35], a[108:111], v[80:83], v[32:35]
    ds_read2st64_b32 v[72:73], v18 offset0:160 offset1:161
    ds_read2st64_b32 v[74:75], v18 offset0:162 offset1:163
    v_mfma_f32_16x16x32_bf16 v[36:39], a[108:111], v[84:87], v[36:39]
    ds_read2st64_b32 v[76:77], v19 offset0:160 offset1:161
    ds_read2st64_b32 v[78:79], v19 offset0:162 offset1:163
    v_mfma_f32_16x16x32_bf16 v[48:51], a[112:115], v[80:83], v[48:51]
    v_mfma_f32_16x16x32_bf16 v[52:55], a[112:115], v[84:87], v[52:55]
    buffer_load_dwordx4 v[204:207], v20, s[4:7], s94 offen sc1
    v_mfma_f32_16x16x32_bf16 v[64:67], a[116:119], v[80:83], v[64:67]
    v_mfma_f32_16x16x32_bf16 v[68:71], a[116:119], v[84:87], v[68:71]
    s_waitcnt lgkmcnt(0)
    v_mfma_f32_16x16x32_bf16 v[32:35], a[120:123], v[72:75], v[32:35]
    ds_read2st64_b32 v[80:81], v18 offset0:176 offset1:177
    ds_read2st64_b32 v[82:83], v18 offset0:178 offset1:179
    v_mfma_f32_16x16x32_bf16 v[36:39], a[120:123], v[76:79], v[36:39]
    ds_read2st64_b32 v[84:85], v19 offset0:176 offset1:177
    ds_read2st64_b32 v[86:87], v19 offset0:178 offset1:179
    v_mfma_f32_16x16x32_bf16 v[48:51], a[124:127], v[72:75], v[48:51]
    v_mfma_f32_16x16x32_bf16 v[52:55], a[124:127], v[76:79], v[52:55]
    buffer_load_dwordx4 v[200:203], v21, s[4:7], s94 offen sc1
    v_mfma_f32_16x16x32_bf16 v[64:67], a[128:131], v[72:75], v[64:67]
    v_mfma_f32_16x16x32_bf16 v[68:71], a[128:131], v[76:79], v[68:71]
    s_waitcnt lgkmcnt(0)
    v_mfma_f32_16x16x32_bf16 v[32:35], a[132:135], v[80:83], v[32:35]
    ds_read2st64_b32 v[72:73], v18 offset0:192 offset1:193
    ds_read2st64_b32 v[74:75], v18 offset0:194 offset1:195
    v_mfma_f32_16x16x32_bf16 v[36:39], a[132:135], v[84:87], v[36:39]
    ds_read2st64_b32 v[76:77], v19 offset0:192 offset1:193
    ds_read2st64_b32 v[78:79], v19 offset0:194 offset1:195
    v_mfma_f32_16x16x32_bf16 v[48:51], a[136:139], v[80:83], v[48:51]
    v_mfma_f32_16x16x32_bf16 v[52:55], a[136:139], v[84:87], v[52:55]
    buffer_load_dwordx4 v[196:199], v20, s[4:7], s95 offen sc1
    v_mfma_f32_16x16x32_bf16 v[64:67], a[140:143], v[80:83], v[64:67]
    v_mfma_f32_16x16x32_bf16 v[68:71], a[140:143], v[84:87], v[68:71]
    s_waitcnt lgkmcnt(0)
    v_mfma_f32_16x16x32_bf16 v[32:35], a[144:147], v[72:75], v[32:35]
    ds_read2st64_b32 v[80:81], v18 offset0:208 offset1:209
    ds_read2st64_b32 v[82:83], v18 offset0:210 offset1:211
    v_mfma_f32_16x16x32_bf16 v[36:39], a[144:147], v[76:79], v[36:39]
    ds_read2st64_b32 v[84:85], v19 offset0:208 offset1:209
    ds_read2st64_b32 v[86:87], v19 offset0:210 offset1:211
    v_mfma_f32_16x16x32_bf16 v[48:51], a[148:151], v[72:75], v[48:51]
    v_mfma_f32_16x16x32_bf16 v[52:55], a[148:151], v[76:79], v[52:55]
    buffer_load_dwordx4 v[192:195], v21, s[4:7], s95 offen sc1
    v_mfma_f32_16x16x32_bf16 v[64:67], a[152:155], v[72:75], v[64:67]
    v_mfma_f32_16x16x32_bf16 v[68:71], a[152:155], v[76:79], v[68:71]
    s_waitcnt lgkmcnt(0)
    v_mfma_f32_16x16x32_bf16 v[32:35], a[156:159], v[80:83], v[32:35]
    ds_read2st64_b32 v[72:73], v18 offset0:224 offset1:225
    ds_read2st64_b32 v[74:75], v18 offset0:226 offset1:227
    v_mfma_f32_16x16x32_bf16 v[36:39], a[156:159], v[84:87], v[36:39]
    ds_read2st64_b32 v[76:77], v19 offset0:224 offset1:225
    ds_read2st64_b32 v[78:79], v19 offset0:226 offset1:227
    v_mfma_f32_16x16x32_bf16 v[48:51], a[160:163], v[80:83], v[48:51]
    v_mfma_f32_16x16x32_bf16 v[52:55], a[160:163], v[84:87], v[52:55]
    buffer_load_dwordx4 v[188:191], v20, s[4:7], s8 offen sc1
    v_mfma_f32_16x16x32_bf16 v[64:67], a[164:167], v[80:83], v[64:67]
    v_mfma_f32_16x16x32_bf16 v[68:71], a[164:167], v[84:87], v[68:71]
    s_waitcnt lgkmcnt(0)
    v_mfma_f32_16x16x32_bf16 v[32:35], a[168:171], v[72:75], v[32:35]
    ds_read2st64_b32 v[80:81], v18 offset0:240 offset1:241
    ds_read2st64_b32 v[82:83], v18 offset0:242 offset1:243
    v_mfma_f32_16x16x32_bf16 v[36:39], a[168:171], v[76:79], v[36:39]
    ds_read2st64_b32 v[84:85], v19 offset0:240 offset1:241
    ds_read2st64_b32 v[86:87], v19 offset0:242 offset1:243
    v_mfma_f32_16x16x32_bf16 v[48:51], a[172:175], v[72:75], v[48:51]
    v_mfma_f32_16x16x32_bf16 v[52:55], a[172:175], v[76:79], v[52:55]
    buffer_load_dwordx4 v[184:187], v21, s[4:7], s8 offen sc1
    v_mfma_f32_16x16x32_bf16 v[64:67], a[176:179], v[72:75], v[64:67]
    v_mfma_f32_16x16x32_bf16 v[68:71], a[176:179], v[76:79], v[68:71]
    s_waitcnt lgkmcnt(0)
    v_mfma_f32_16x16x32_bf16 v[32:35], a[180:183], v[80:83], v[32:35]
    v_mfma_f32_16x16x32_bf16 v[36:39], a[180:183], v[84:87], v[36:39]
    v_mfma_f32_16x16x32_bf16 v[48:51], a[184:187], v[80:83], v[48:51]
    v_mfma_f32_16x16x32_bf16 v[52:55], a[184:187], v[84:87], v[52:55]
    buffer_load_dwordx4 v[180:183], v20, s[4:7], s9 offen sc1
    v_mfma_f32_16x16x32_bf16 v[64:67], a[188:191], v[80:83], v[64:67]
    v_mfma_f32_16x16x32_bf16 v[68:71], a[188:191], v[84:87], v[68:71]
    s_nop 7
    v_pk_fma_f32 v[72:73], v[116:117], v[132:133], v[104:105] op_sel:[0,1,0] op_sel_hi:[1,1,1] neg_lo:[0,1,0] neg_hi:[0,1,0]
    v_pk_fma_f32 v[76:77], v[116:117], v[134:135], v[104:105] op_sel:[0,1,0] op_sel_hi:[1,1,1] neg_lo:[0,1,0] neg_hi:[0,1,0]
    v_pk_fma_f32 v[74:75], v[118:119], v[132:133], v[106:107] op_sel:[0,1,0] op_sel_hi:[1,1,1] neg_lo:[0,1,0] neg_hi:[0,1,0]
    v_pk_fma_f32 v[78:79], v[118:119], v[134:135], v[106:107] op_sel:[0,1,0] op_sel_hi:[1,1,1] neg_lo:[0,1,0] neg_hi:[0,1,0]
    v_pk_fma_f32 v[32:33], v[32:33], v[132:133], v[72:73] op_sel_hi:[1,0,1]
    v_pk_fma_f32 v[36:37], v[36:37], v[134:135], v[76:77] op_sel_hi:[1,0,1]
    v_pk_fma_f32 v[34:35], v[34:35], v[132:133], v[74:75] op_sel_hi:[1,0,1]
    v_pk_fma_f32 v[38:39], v[38:39], v[134:135], v[78:79] op_sel_hi:[1,0,1]
    v_max_f32 v32, 0, v32
    v_max_f32 v36, 0, v36
    v_max_f32 v33, 0, v33
    v_max_f32 v37, 0, v37
    v_max_f32 v34, 0, v34
    v_max_f32 v38, 0, v38
    v_max_f32 v35, 0, v35
    v_max_f32 v39, 0, v39
    v_pk_mul_f32 v[32:33], v[32:33], v[32:33]
    v_pk_mul_f32 v[36:37], v[36:37], v[36:37]
    v_pk_mul_f32 v[34:35], v[34:35], v[34:35]
    v_pk_mul_f32 v[38:39], v[38:39], v[38:39]
    v_cvt_pk_bf16_f32 v32, v32, v33
    v_cvt_pk_bf16_f32 v36, v36, v37
    v_cvt_pk_bf16_f32 v33, v34, v35
    v_cvt_pk_bf16_f32 v37, v38, v39
    buffer_store_dwordx2 v[32:33], v8, s[4:7], s59 offen offset:0 sc1
    buffer_store_dwordx2 v[36:37], v8, s[4:7], s59 offen offset:256 sc1
    v_pk_fma_f32 v[72:73], v[120:121], v[132:133], v[108:109] op_sel:[0,1,0] op_sel_hi:[1,1,1] neg_lo:[0,1,0] neg_hi:[0,1,0]
    v_pk_fma_f32 v[76:77], v[120:121], v[134:135], v[108:109] op_sel:[0,1,0] op_sel_hi:[1,1,1] neg_lo:[0,1,0] neg_hi:[0,1,0]
    v_pk_fma_f32 v[74:75], v[122:123], v[132:133], v[110:111] op_sel:[0,1,0] op_sel_hi:[1,1,1] neg_lo:[0,1,0] neg_hi:[0,1,0]
    v_pk_fma_f32 v[78:79], v[122:123], v[134:135], v[110:111] op_sel:[0,1,0] op_sel_hi:[1,1,1] neg_lo:[0,1,0] neg_hi:[0,1,0]
    v_pk_fma_f32 v[48:49], v[48:49], v[132:133], v[72:73] op_sel_hi:[1,0,1]
    v_pk_fma_f32 v[52:53], v[52:53], v[134:135], v[76:77] op_sel_hi:[1,0,1]
    v_pk_fma_f32 v[50:51], v[50:51], v[132:133], v[74:75] op_sel_hi:[1,0,1]
    v_pk_fma_f32 v[54:55], v[54:55], v[134:135], v[78:79] op_sel_hi:[1,0,1]
    v_max_f32 v48, 0, v48
    v_max_f32 v52, 0, v52
    v_max_f32 v49, 0, v49
    v_max_f32 v53, 0, v53
    v_max_f32 v50, 0, v50
    v_max_f32 v54, 0, v54
    v_max_f32 v51, 0, v51
    v_max_f32 v55, 0, v55
    v_pk_mul_f32 v[48:49], v[48:49], v[48:49]
    v_pk_mul_f32 v[52:53], v[52:53], v[52:53]
    v_pk_mul_f32 v[50:51], v[50:51], v[50:51]
    v_pk_mul_f32 v[54:55], v[54:55], v[54:55]
    v_cvt_pk_bf16_f32 v48, v48, v49
    v_cvt_pk_bf16_f32 v52, v52, v53
    v_cvt_pk_bf16_f32 v49, v50, v51
    v_cvt_pk_bf16_f32 v53, v54, v55
    buffer_store_dwordx2 v[48:49], v9, s[4:7], s59 offen offset:0 sc1
    buffer_store_dwordx2 v[52:53], v9, s[4:7], s59 offen offset:256 sc1
    v_pk_fma_f32 v[72:73], v[124:125], v[132:133], v[112:113] op_sel:[0,1,0] op_sel_hi:[1,1,1] neg_lo:[0,1,0] neg_hi:[0,1,0]
    v_pk_fma_f32 v[76:77], v[124:125], v[134:135], v[112:113] op_sel:[0,1,0] op_sel_hi:[1,1,1] neg_lo:[0,1,0] neg_hi:[0,1,0]
    v_pk_fma_f32 v[74:75], v[126:127], v[132:133], v[114:115] op_sel:[0,1,0] op_sel_hi:[1,1,1] neg_lo:[0,1,0] neg_hi:[0,1,0]
    v_pk_fma_f32 v[78:79], v[126:127], v[134:135], v[114:115] op_sel:[0,1,0] op_sel_hi:[1,1,1] neg_lo:[0,1,0] neg_hi:[0,1,0]
    v_pk_fma_f32 v[64:65], v[64:65], v[132:133], v[72:73] op_sel_hi:[1,0,1]
    v_pk_fma_f32 v[68:69], v[68:69], v[134:135], v[76:77] op_sel_hi:[1,0,1]
    v_pk_fma_f32 v[66:67], v[66:67], v[132:133], v[74:75] op_sel_hi:[1,0,1]
    v_pk_fma_f32 v[70:71], v[70:71], v[134:135], v[78:79] op_sel_hi:[1,0,1]
    v_max_f32 v64, 0, v64
    v_max_f32 v68, 0, v68
    v_max_f32 v65, 0, v65
    v_max_f32 v69, 0, v69
    v_max_f32 v66, 0, v66
    v_max_f32 v70, 0, v70
    v_max_f32 v67, 0, v67
    v_max_f32 v71, 0, v71
    v_pk_mul_f32 v[64:65], v[64:65], v[64:65]
    v_pk_mul_f32 v[68:69], v[68:69], v[68:69]
    v_pk_mul_f32 v[66:67], v[66:67], v[66:67]
    v_pk_mul_f32 v[70:71], v[70:71], v[70:71]
    v_cvt_pk_bf16_f32 v64, v64, v65
    v_cvt_pk_bf16_f32 v68, v68, v69
    v_cvt_pk_bf16_f32 v65, v66, v67
    v_cvt_pk_bf16_f32 v69, v70, v71
    buffer_store_dwordx2 v[64:65], v10, s[4:7], s59 offen offset:0 sc1
    buffer_store_dwordx2 v[68:69], v10, s[4:7], s59 offen offset:256 sc1
    v_and_b32 v8, 31, v2
    v_lshrrev_b32 v9, 5, v2
    s_lshl_b32 s58, s97, 7
    s_lshl_b32 s60, s52, 5
    s_add_u32 s58, s58, s60
    v_lshlrev_b32 v10, 3, v9
    v_add_u32 v10, s58, v10
    v_lshlrev_b32 v11, 1, v10
    v_add_u32 v11, 135296, v11
    s_lshl_b32 s60, s96, 6
    v_add_u32 v12, s60, v8
    v_lshlrev_b32 v19, 11, v10
    v_lshl_add_u32 v19, v12, 2, v19
    v_add_u32 v19, 4194304, v19
    v_lshl_add_u32 v12, v12, 10, v10
    v_add_u32 v16, 19972096, v15
    v_add_u32 v17, 20004864, v15
    v_lshlrev_b32 v13, 4, v2
    s_lshl_b32 s56, s52, 11
    s_add_u32 s56, s56, 65536
    v_add_u32 v14, s56, v13
    s_lshl_b32 s56, s52, 13
    s_add_u32 s56, s56, 65536
    v_add_u32 v13, s56, v13
    buffer_load_dword v18, v16, s[4:7], 0 offen sc1
    buffer_load_dwordx4 v[176:179], v21, s[4:7], s9 offen sc1
    buffer_load_dwordx4 v[172:175], v20, s[4:7], s10 offen sc1
    buffer_load_dwordx4 v[168:171], v21, s[4:7], s10 offen sc1
    buffer_load_dwordx4 v[164:167], v20, s[4:7], s11 offen sc1
    buffer_load_dwordx4 v[160:163], v21, s[4:7], s11 offen sc1
    buffer_load_dwordx4 v[156:159], v20, s[4:7], s12 offen sc1
    buffer_load_dwordx4 v[152:155], v21, s[4:7], s12 offen sc1
    buffer_load_dwordx4 v[148:151], v20, s[4:7], s13 offen sc1
    buffer_load_dwordx4 v[144:147], v21, s[4:7], s13 offen sc1
    s_waitcnt vmcnt(10)
    s_barrier
    s_cmp_lg_u32 s52, 0
    s_cbranch_scc1 L_fl_5
    s_lshl_b32 s56, s96, 3
    s_add_u32 s56, s56, s97
    s_lshl_b32 s56, s56, 6
    s_add_u32 s56, s56, 20004864
    v_mov_b32 v92, s56
    v_mov_b32 v93, s55
    s_mov_b64 exec, 1
    buffer_store_dword v93, v92, s[4:7], 0 offen sc1
    s_mov_b64 exec, -1
L_fl_5:
    v_mov_b32 v24, 0
    v_mov_b32 v25, 0
    v_mov_b32 v26, 0
    v_mov_b32 v27, 0
    v_mov_b32 v28, 0
    v_mov_b32 v29, 0
    v_mov_b32 v30, 0
    v_mov_b32 v31, 0
    v_mov_b32 v32, 0
    v_mov_b32 v33, 0
    v_mov_b32 v34, 0
    v_mov_b32 v35, 0
    v_mov_b32 v36, 0
    v_mov_b32 v37, 0
    v_mov_b32 v38, 0
    v_mov_b32 v39, 0
    v_mov_b32 v40, 0
    v_mov_b32 v41, 0
    v_mov_b32 v42, 0
    v_mov_b32 v43, 0
    v_mov_b32 v44, 0
    v_mov_b32 v45, 0
    v_mov_b32 v46, 0
    v_mov_b32 v47, 0
    v_mov_b32 v48, 0
    v_mov_b32 v49, 0
    v_mov_b32 v50, 0
    v_mov_b32 v51, 0
    v_mov_b32 v52, 0
    v_mov_b32 v53, 0
    v_mov_b32 v54, 0
    v_mov_b32 v55, 0
    v_mov_b32 v56, 0
    v_mov_b32 v57, 0
    v_mov_b32 v58, 0
    v_mov_b32 v59, 0
    v_mov_b32 v60, 0
    v_mov_b32 v61, 0
    v_mov_b32 v62, 0
    v_mov_b32 v63, 0
    v_mov_b32 v64, 0
    v_mov_b32 v65, 0
    v_mov_b32 v66, 0
    v_mov_b32 v67, 0
    v_mov_b32 v68, 0
    v_mov_b32 v69, 0
    v_mov_b32 v70, 0
    v_mov_b32 v71, 0
    v_mov_b32 v72, 0
    v_mov_b32 v73, 0
    v_mov_b32 v74, 0
    v_mov_b32 v75, 0
    v_mov_b32 v76, 0
    v_mov_b32 v77, 0
    v_mov_b32 v78, 0
    v_mov_b32 v79, 0
    v_mov_b32 v80, 0
    v_mov_b32 v81, 0
    v_mov_b32 v82, 0
    v_mov_b32 v83, 0
    v_mov_b32 v84, 0
    v_mov_b32 v85, 0
    v_mov_b32 v86, 0
    v_mov_b32 v87, 0
    s_waitcnt vmcnt(9)
    v_cmp_ne_u32 vcc, s55, v18
    s_nop 1
    s_cbranch_vccz p3a_done
    s_mov_b32 s56, 0
p3a:
    s_mov_b32 s57, 0
    buffer_load_dword v18, v16, s[4:7], s57 offen sc1
    s_waitcnt vmcnt(0)
    v_xor_b32 v18, s55, v18
    v_cmp_ne_u32 vcc, 0, v18
    s_add_u32 s56, s56, 1
    s_cmp_ge_u32 s56, 200000
    s_cbranch_scc1 p3a_done
    s_cbranch_vccz p3a_done
    s_mov_b64 exec, vcc
    s_sleep 2
    s_branch p3a
p3a_done:
    s_mov_b64 exec, -1
    buffer_load_dwordx4 a[0:3], v22, s[4:7], s80 offen sc1
    buffer_load_dwordx4 a[4:7], v22, s[4:7], s81 offen sc1
    buffer_load_dwordx4 a[8:11], v22, s[4:7], s82 offen sc1
    buffer_load_dwordx4 a[12:15], v22, s[4:7], s83 offen sc1
    buffer_load_dwordx4 a[16:19], v22, s[4:7], s84 offen sc1
    buffer_load_dwordx4 a[20:23], v22, s[4:7], s85 offen sc1
    ds_read_b128 v[112:115], v11 offset:0
    ds_read_b128 v[116:119], v11 offset:32
    s_mov_b32 s61, 32768
    s_waitcnt vmcnt(5)
    v_mfma_f32_32x32x16_bf16 v[24:39], a[192:195], a[0:3], v[24:39]
    v_mfma_f32_32x32x16_bf16 v[40:55], a[196:199], a[0:3], v[40:55]
    buffer_load_dwordx4 a[24:27], v22, s[4:7], s86 offen sc1
    s_waitcnt vmcnt(5)
    v_mfma_f32_32x32x16_bf16 v[24:39], a[200:203], a[4:7], v[24:39]
    v_mfma_f32_32x32x16_bf16 v[40:55], a[204:207], a[4:7], v[40:55]
    buffer_load_dwordx4 a[28:31], v22, s[4:7], s87 offen sc1
    s_waitcnt vmcnt(5)
    v_mfma_f32_32x32x16_bf16 v[24:39], a[208:211], a[8:11], v[24:39]
    v_mfma_f32_32x32x16_bf16 v[40:55], a[212:215], a[8:11], v[40:55]
    buffer_load_dwordx4 a[32:35], v22, s[4:7], s88 offen sc1
    s_waitcnt vmcnt(5)
    v_mfma_f32_32x32x16_bf16 v[24:39], a[216:219], a[12:15], v[24:39]
    v_mfma_f32_32x32x16_bf16 v[40:55], a[220:223], a[12:15], v[40:55]
    buffer_load_dwordx4 a[36:39], v22, s[4:7], s89 offen sc1
    s_waitcnt vmcnt(5)
    v_mfma_f32_32x32x16_bf16 v[24:39], a[224:227], a[16:19], v[24:39]
    v_mfma_f32_32x32x16_bf16 v[40:55], a[228:231], a[16:19], v[40:55]
    buffer_load_dwordx4 a[40:43], v22, s[4:7], s90 offen sc1
    s_waitcnt vmcnt(5)
    v_mfma_f32_32x32x16_bf16 v[24:39], a[232:235], a[20:23], v[24:39]
    v_mfma_f32_32x32x16_bf16 v[40:55], a[236:239], a[20:23], v[40:55]
    buffer_load_dwordx4 a[44:47], v22, s[4:7], s91 offen sc1
    s_waitcnt vmcnt(5)
    v_mfma_f32_32x32x16_bf16 v[24:39], a[240:243], a[24:27], v[24:39]
    v_mfma_f32_32x32x16_bf16 v[40:55], a[244:247], a[24:27], v[40:55]
    buffer_load_dwordx4 a[48:51], v22, s[4:7], s92 offen sc1
    s_waitcnt vmcnt(5)
    v_mfma_f32_32x32x16_bf16 v[24:39], a[248:251], a[28:31], v[24:39]
    v_mfma_f32_32x32x16_bf16 v[40:55], a[252:255], a[28:31], v[40:55]
    buffer_load_dwordx4 a[52:55], v22, s[4:7], s93 offen sc1
    s_waitcnt vmcnt(5)
    v_mfma_f32_32x32x16_bf16 v[24:39], v[252:255], a[32:35], v[24:39]
    v_mfma_f32_32x32x16_bf16 v[40:55], v[248:251], a[32:35], v[40:55]
    buffer_load_dwordx4 a[56:59], v22, s[4:7], s94 offen sc1
    s_waitcnt vmcnt(5)
    v_mfma_f32_32x32x16_bf16 v[24:39], v[244:247], a[36:39], v[24:39]
    v_mfma_f32_32x32x16_bf16 v[40:55], v[240:243], a[36:39], v[40:55]
    buffer_load_dwordx4 a[60:63], v22, s[4:7], s95 offen sc1
    s_waitcnt vmcnt(5)
    v_mfma_f32_32x32x16_bf16 v[24:39], v[236:239], a[40:43], v[24:39]
    v_mfma_f32_32x32x16_bf16 v[40:55], v[232:235], a[40:43], v[40:55]
    buffer_load_dwordx4 a[64:67], v22, s[4:7], s8 offen sc1
    s_waitcnt vmcnt(5)
    v_mfma_f32_32x32x16_bf16 v[24:39], v[228:231], a[44:47], v[24:39]
    v_mfma_f32_32x32x16_bf16 v[40:55], v[224:227], a[44:47], v[40:55]
    buffer_load_dwordx4 a[68:71], v22, s[4:7], s9 offen sc1
    s_waitcnt vmcnt(5)
    v_mfma_f32_32x32x16_bf16 v[24:39], v[220:223], a[48:51], v[24:39]
    v_mfma_f32_32x32x16_bf16 v[40:55], v[216:219], a[48:51], v[40:55]
    buffer_load_dword v18, v17, s[4:7], 0 offen sc1
    buffer_load_dwordx4 a[72:75], v22, s[4:7], s10 offen sc1
    s_waitcnt vmcnt(6)
    v_mfma_f32_32x32x16_bf16 v[24:39], v[212:215], a[52:55], v[24:39]
    v_mfma_f32_32x32x16_bf16 v[40:55], v[208:211], a[52:55], v[40:55]
    buffer_load_dwordx4 a[76:79], v22, s[4:7], s11 offen sc1
    s_waitcnt vmcnt(6)
    v_mfma_f32_32x32x16_bf16 v[24:39], v[204:207], a[56:59], v[24:39]
    v_mfma_f32_32x32x16_bf16 v[40:55], v[200:203], a[56:59], v[40:55]
    buffer_load_dwordx4 a[80:83], v22, s[4:7], s12 offen sc1
    s_waitcnt vmcnt(6)
    v_mfma_f32_32x32x16_bf16 v[24:39], v[196:199], a[60:63], v[24:39]
    v_mfma_f32_32x32x16_bf16 v[40:55], v[192:195], a[60:63], v[40:55]
    buffer_load_dwordx4 a[84:87], v22, s[4:7], s13 offen sc1
    s_waitcnt vmcnt(6)
    v_mfma_f32_32x32x16_bf16 v[24:39], v[188:191], a[64:67], v[24:39]
    v_mfma_f32_32x32x16_bf16 v[40:55], v[184:187], a[64:67], v[40:55]
    s_waitcnt vmcnt(4)
    v_cmp_ne_u32 vcc, s55, v18
    s_nop 1
    s_cbranch_vccz p3b_done
    s_mov_b32 s56, 0
p3b:
    s_mov_b32 s57, 0
    buffer_load_dword v18, v17, s[4:7], s57 offen sc1
    s_waitcnt vmcnt(0)
    v_xor_b32 v18, s55, v18
    v_cmp_ne_u32 vcc, 0, v18
    s_add_u32 s56, s56, 1
    s_cmp_ge_u32 s56, 200000
    s_cbranch_scc1 p3b_done
    s_cbranch_vccz p3b_done
    s_mov_b64 exec, vcc
    s_sleep 2
    s_branch p3b
p3b_done:
    s_mov_b64 exec, -1
    buffer_load_dwordx4 a[88:91], v23, s[4:7], s80 offen sc1
    v_mfma_f32_32x32x16_bf16 v[24:39], v[180:183], a[68:71], v[24:39]
    v_mfma_f32_32x32x16_bf16 v[40:55], v[176:179], a[68:71], v[40:55]
    buffer_load_dwordx4 a[92:95], v23, s[4:7], s81 offen sc1
    s_waitcnt vmcnt(5)
    v_mfma_f32_32x32x16_bf16 v[24:39], v[172:175], a[72:75], v[24:39]
    v_mfma_f32_32x32x16_bf16 v[40:55], v[168:171], a[72:75], v[40:55]
    buffer_load_dwordx4 a[96:99], v23, s[4:7], s82 offen sc1
    s_waitcnt vmcnt(5)
    v_mfma_f32_32x32x16_bf16 v[24:39], v[164:167], a[76:79], v[24:39]
    v_mfma_f32_32x32x16_bf16 v[40:55], v[160:163], a[76:79], v[40:55]
    buffer_load_dwordx4 a[100:103], v23, s[4:7], s83 offen sc1
    s_waitcnt vmcnt(5)
    v_mfma_f32_32x32x16_bf16 v[24:39], v[156:159], a[80:83], v[24:39]
    v_mfma_f32_32x32x16_bf16 v[40:55], v[152:155], a[80:83], v[40:55]
    buffer_load_dwordx4 a[104:107], v23, s[4:7], s84 offen sc1
    s_waitcnt vmcnt(5)
    v_mfma_f32_32x32x16_bf16 v[24:39], v[148:151], a[84:87], v[24:39]
    v_mfma_f32_32x32x16_bf16 v[40:55], v[144:147], a[84:87], v[40:55]
    buffer_load_dwordx4 a[108:111], v23, s[4:7], s85 offen sc1
    s_waitcnt vmcnt(5)
    v_mfma_f32_32x32x16_bf16 v[56:71], a[192:195], a[88:91], v[56:71]
    v_mfma_f32_32x32x16_bf16 v[72:87], a[196:199], a[88:91], v[72:87]
    buffer_load_dwordx4 a[112:115], v23, s[4:7], s86 offen sc1
    s_mov_b32 s57, 0
    buffer_load_dword v96, v19, s[4:7], s57 offen offset:0 sc1
    s_mov_b32 s57, 8192
    buffer_load_dword v97, v19, s[4:7], s57 offen offset:0 sc1
    s_mov_b32 s57, 32768
    buffer_load_dword v98, v19, s[4:7], s57 offen offset:0 sc1
    s_mov_b32 s57, 40960
    buffer_load_dword v99, v19, s[4:7], s57 offen offset:0 sc1
    s_mov_b32 s57, 0
    buffer_load_dword v100, v19, s[4:7], s57 offen offset:128 sc1
    s_mov_b32 s57, 8192
    buffer_load_dword v101, v19, s[4:7], s57 offen offset:128 sc1
    s_mov_b32 s57, 32768
    buffer_load_dword v102, v19, s[4:7], s57 offen offset:128 sc1
    s_mov_b32 s57, 40960
    buffer_load_dword v103, v19, s[4:7], s57 offen offset:128 sc1
    buffer_load_dwordx2 v[104:105], v10, s[28:31], 0 offen offset:0
    buffer_load_dwordx2 v[106:107], v10, s[28:31], 0 offen offset:16
    s_waitcnt vmcnt(15)
    v_mfma_f32_32x32x16_bf16 v[56:71], a[200:203], a[92:95], v[56:71]
    ds_write_b128 v14, v[24:27] offset:0
    ds_write_b128 v14, v[28:31] offset:1024
    ds_write_b128 v14, v[32:35] offset:8192
    v_mfma_f32_32x32x16_bf16 v[72:87], a[204:207], a[92:95], v[72:87]
    ds_write_b128 v14, v[36:39] offset:9216
    ds_write_b128 v14, v[40:43] offset:16384
    ds_write_b128 v14, v[44:47] offset:17408
    buffer_load_dwordx4 a[116:119], v23, s[4:7], s87 offen sc1
    s_waitcnt vmcnt(15)
    v_mfma_f32_32x32x16_bf16 v[56:71], a[208:211], a[96:99], v[56:71]
    ds_write_b128 v14, v[48:51] offset:24576
    ds_write_b128 v14, v[52:55] offset:25600
    v_mfma_f32_32x32x16_bf16 v[72:87], a[212:215], a[96:99], v[72:87]
    buffer_load_dwordx4 a[120:123], v23, s[4:7], s88 offen sc1
    s_waitcnt vmcnt(15)
    v_mfma_f32_32x32x16_bf16 v[56:71], a[216:219], a[100:103], v[56:71]
    v_mfma_f32_32x32x16_bf16 v[72:87], a[220:223], a[100:103], v[72:87]
    buffer_load_dwordx4 a[124:127], v23, s[4:7], s89 offen sc1
    s_waitcnt vmcnt(15)
    v_mfma_f32_32x32x16_bf16 v[56:71], a[224:227], a[104:107], v[56:71]
    v_mfma_f32_32x32x16_bf16 v[72:87], a[228:231], a[104:107], v[72:87]
    buffer_load_dwordx4 a[128:131], v23, s[4:7], s90 offen sc1
    s_waitcnt vmcnt(15)
    v_mfma_f32_32x32x16_bf16 v[56:71], a[232:235], a[108:111], v[56:71]
    v_mfma_f32_32x32x16_bf16 v[72:87], a[236:239], a[108:111], v[72:87]
    buffer_load_dwordx4 a[132:135], v23, s[4:7], s91 offen sc1
    s_waitcnt vmcnt(15)
    s_waitcnt lgkmcnt(0)
    s_barrier
    v_mfma_f32_32x32x16_bf16 v[56:71], a[240:243], a[112:115], v[56:71]
    ds_read_b128 v[24:27], v13 offset:0
    ds_read_b128 v[28:31], v13 offset:2048
    ds_read_b128 v[32:35], v13 offset:4096
    v_mfma_f32_32x32x16_bf16 v[72:87], a[244:247], a[112:115], v[72:87]
    ds_read_b128 v[36:39], v13 offset:6144
    ds_read_b128 v[40:43], v13 offset:1024
    ds_read_b128 v[44:47], v13 offset:3072
    buffer_load_dwordx4 a[136:139], v23, s[4:7], s92 offen sc1
    s_waitcnt vmcnt(5)
    v_mfma_f32_32x32x16_bf16 v[56:71], a[248:251], a[116:119], v[56:71]
    ds_read_b128 v[48:51], v13 offset:5120
    ds_read_b128 v[52:55], v13 offset:7168
    v_mfma_f32_32x32x16_bf16 v[72:87], a[252:255], a[116:119], v[72:87]
    buffer_load_dwordx4 a[140:143], v23, s[4:7], s93 offen sc1
    s_waitcnt vmcnt(5)
    v_mfma_f32_32x32x16_bf16 v[56:71], v[252:255], a[120:123], v[56:71]
    v_mfma_f32_32x32x16_bf16 v[72:87], v[248:251], a[120:123], v[72:87]
    buffer_load_dwordx4 a[144:147], v23, s[4:7], s94 offen sc1
    s_waitcnt vmcnt(5)
    v_mfma_f32_32x32x16_bf16 v[56:71], v[244:247], a[124:127], v[56:71]
    v_mfma_f32_32x32x16_bf16 v[72:87], v[240:243], a[124:127], v[72:87]
    buffer_load_dwordx4 a[148:151], v23, s[4:7], s95 offen sc1
    s_waitcnt vmcnt(5)
    s_waitcnt lgkmcnt(0)
    v_mfma_f32_32x32x16_bf16 v[56:71], v[236:239], a[128:131], v[56:71]
    v_lshlrev_b32 v120, 16, v104
    v_and_b32 v121, 0xffff0000, v104
    v_lshlrev_b32 v122, 16, v105
    v_mfma_f32_32x32x16_bf16 v[72:87], v[232:235], a[128:131], v[72:87]
    v_and_b32 v123, 0xffff0000, v105
    v_pk_add_f32 v[24:25], v[24:25], v[28:29]
    v_pk_add_f32 v[32:33], v[32:33], v[36:37]
    buffer_load_dwordx4 a[152:155], v23, s[4:7], s8 offen sc1
    s_waitcnt vmcnt(5)
    v_mfma_f32_32x32x16_bf16 v[56:71], v[228:231], a[132:135], v[56:71]
    v_pk_add_f32 v[26:27], v[26:27], v[30:31]
    v_pk_add_f32 v[34:35], v[34:35], v[38:39]
    v_pk_add_f32 v[24:25], v[24:25], v[120:121]
    v_mfma_f32_32x32x16_bf16 v[72:87], v[224:227], a[132:135], v[72:87]
    v_pk_add_f32 v[26:27], v[26:27], v[122:123]
    v_lshlrev_b32 v120, 16, v96
    v_and_b32 v121, 0xffff0000, v96
    buffer_load_dwordx4 a[156:159], v23, s[4:7], s9 offen sc1
    s_waitcnt vmcnt(5)
    v_mfma_f32_32x32x16_bf16 v[56:71], v[220:223], a[136:139], v[56:71]
    v_lshlrev_b32 v122, 16, v97
    v_and_b32 v123, 0xffff0000, v97
    v_pk_add_f32 v[24:25], v[24:25], v[32:33]
    v_mfma_f32_32x32x16_bf16 v[72:87], v[216:219], a[136:139], v[72:87]
    v_pk_add_f32 v[26:27], v[26:27], v[34:35]
    v_pk_fma_f32 v[24:25], v[24:25], v[112:113], v[120:121]
    v_pk_fma_f32 v[26:27], v[26:27], v[114:115], v[122:123]
    buffer_load_dwordx4 a[160:163], v23, s[4:7], s10 offen sc1
    s_waitcnt vmcnt(5)
    v_mfma_f32_32x32x16_bf16 v[56:71], v[212:215], a[140:143], v[56:71]
    v_cvt_pk_bf16_f32 v24, v24, v25
    v_cvt_pk_bf16_f32 v25, v26, v27
    buffer_store_dwordx2 v[24:25], v12, s[48:51], 0 offen offset:0
    v_mfma_f32_32x32x16_bf16 v[72:87], v[208:211], a[140:143], v[72:87]
    v_lshlrev_b32 v120, 16, v106
    v_and_b32 v121, 0xffff0000, v106
    v_lshlrev_b32 v122, 16, v107
    buffer_load_dwordx4 a[164:167], v23, s[4:7], s11 offen sc1
    s_waitcnt vmcnt(6)
    v_mfma_f32_32x32x16_bf16 v[56:71], v[204:207], a[144:147], v[56:71]
    v_and_b32 v123, 0xffff0000, v107
    v_pk_add_f32 v[40:41], v[40:41], v[44:45]
    v_pk_add_f32 v[48:49], v[48:49], v[52:53]
    v_mfma_f32_32x32x16_bf16 v[72:87], v[200:203], a[144:147], v[72:87]
    v_pk_add_f32 v[42:43], v[42:43], v[46:47]
    v_pk_add_f32 v[50:51], v[50:51], v[54:55]
    v_pk_add_f32 v[40:41], v[40:41], v[120:121]
    buffer_load_dwordx4 a[168:171], v23, s[4:7], s12 offen sc1
    s_waitcnt vmcnt(6)
    v_mfma_f32_32x32x16_bf16 v[56:71], v[196:199], a[148:151], v[56:71]
    v_pk_add_f32 v[42:43], v[42:43], v[122:123]
    v_lshlrev_b32 v120, 16, v98
    v_and_b32 v121, 0xffff0000, v98
    v_mfma_f32_32x32x16_bf16 v[72:87], v[192:195], a[148:151], v[72:87]
    v_lshlrev_b32 v122, 16, v99
    v_and_b32 v123, 0xffff0000, v99
    v_pk_add_f32 v[40:41], v[40:41], v[48:49]
    buffer_load_dwordx4 a[172:175], v23, s[4:7], s13 offen sc1
    s_waitcnt vmcnt(6)
    v_mfma_f32_32x32x16_bf16 v[56:71], v[188:191], a[152:155], v[56:71]
    v_pk_add_f32 v[42:43], v[42:43], v[50:51]
    v_pk_fma_f32 v[40:41], v[40:41], v[116:117], v[120:121]
    v_pk_fma_f32 v[42:43], v[42:43], v[118:119], v[122:123]
    v_mfma_f32_32x32x16_bf16 v[72:87], v[184:187], a[152:155], v[72:87]
    v_cvt_pk_bf16_f32 v40, v40, v41
    v_cvt_pk_bf16_f32 v41, v42, v43
    buffer_store_dwordx2 v[40:41], v12, s[48:51], 0 offen offset:16
    s_waitcnt vmcnt(6)
    v_mfma_f32_32x32x16_bf16 v[56:71], v[180:183], a[156:159], v[56:71]
    v_mfma_f32_32x32x16_bf16 v[72:87], v[176:179], a[156:159], v[72:87]
    s_waitcnt vmcnt(5)
    v_mfma_f32_32x32x16_bf16 v[56:71], v[172:175], a[160:163], v[56:71]
    v_mfma_f32_32x32x16_bf16 v[72:87], v[168:171], a[160:163], v[72:87]
    s_waitcnt vmcnt(3)
    v_mfma_f32_32x32x16_bf16 v[56:71], v[164:167], a[164:167], v[56:71]
    v_mfma_f32_32x32x16_bf16 v[72:87], v[160:163], a[164:167], v[72:87]
    s_waitcnt vmcnt(2)
    v_mfma_f32_32x32x16_bf16 v[56:71], v[156:159], a[168:171], v[56:71]
    v_mfma_f32_32x32x16_bf16 v[72:87], v[152:155], a[168:171], v[72:87]
    s_waitcnt vmcnt(1)
    v_mfma_f32_32x32x16_bf16 v[56:71], v[148:151], a[172:175], v[56:71]
    v_mfma_f32_32x32x16_bf16 v[72:87], v[144:147], a[172:175], v[72:87]
    s_nop 7
    s_nop 3
    ds_write_b128 v14, v[56:59] offset:32768
    ds_write_b128 v14, v[60:63] offset:33792
    ds_write_b128 v14, v[64:67] offset:40960
    ds_write_b128 v14, v[68:71] offset:41984
    ds_write_b128 v14, v[72:75] offset:49152
    ds_write_b128 v14, v[76:79] offset:50176
    ds_write_b128 v14, v[80:83] offset:57344
    ds_write_b128 v14, v[84:87] offset:58368
    s_waitcnt lgkmcnt(0)
    s_barrier
    ds_read_b128 v[144:147], v13 offset:32768
    ds_read_b128 v[148:151], v13 offset:34816
    ds_read_b128 v[152:155], v13 offset:36864
    ds_read_b128 v[156:159], v13 offset:38912
    ds_read_b128 v[160:163], v13 offset:33792
    ds_read_b128 v[164:167], v13 offset:35840
    ds_read_b128 v[168:171], v13 offset:37888
    ds_read_b128 v[172:175], v13 offset:39936
    s_waitcnt lgkmcnt(4)
    v_lshlrev_b32 v120, 16, v104
    v_and_b32 v121, 0xffff0000, v104
    v_lshlrev_b32 v122, 16, v105
    v_and_b32 v123, 0xffff0000, v105
    v_pk_add_f32 v[144:145], v[144:145], v[148:149]
    v_pk_add_f32 v[152:153], v[152:153], v[156:157]
    v_pk_add_f32 v[146:147], v[146:147], v[150:151]
    v_pk_add_f32 v[154:155], v[154:155], v[158:159]
    v_pk_add_f32 v[144:145], v[144:145], v[120:121]
    v_pk_add_f32 v[146:147], v[146:147], v[122:123]
    v_lshlrev_b32 v120, 16, v100
    v_and_b32 v121, 0xffff0000, v100
    v_lshlrev_b32 v122, 16, v101
    v_and_b32 v123, 0xffff0000, v101
    v_pk_add_f32 v[144:145], v[144:145], v[152:153]
    v_pk_add_f32 v[146:147], v[146:147], v[154:155]
    v_pk_fma_f32 v[144:145], v[144:145], v[112:113], v[120:121]
    v_pk_fma_f32 v[146:147], v[146:147], v[114:115], v[122:123]
    v_cvt_pk_bf16_f32 v144, v144, v145
    v_cvt_pk_bf16_f32 v145, v146, v147
    buffer_store_dwordx2 v[144:145], v12, s[48:51], s61 offen offset:0
    s_waitcnt lgkmcnt(0)
    v_lshlrev_b32 v120, 16, v106
    v_and_b32 v121, 0xffff0000, v106
    v_lshlrev_b32 v122, 16, v107
    v_and_b32 v123, 0xffff0000, v107
    v_pk_add_f32 v[160:161], v[160:161], v[164:165]
    v_pk_add_f32 v[168:169], v[168:169], v[172:173]
    v_pk_add_f32 v[162:163], v[162:163], v[166:167]
    v_pk_add_f32 v[170:171], v[170:171], v[174:175]
    v_pk_add_f32 v[160:161], v[160:161], v[120:121]
    v_pk_add_f32 v[162:163], v[162:163], v[122:123]
    v_lshlrev_b32 v120, 16, v102
    v_and_b32 v121, 0xffff0000, v102
    v_lshlrev_b32 v122, 16, v103
    v_and_b32 v123, 0xffff0000, v103
    v_pk_add_f32 v[160:161], v[160:161], v[168:169]
    v_pk_add_f32 v[162:163], v[162:163], v[170:171]
    v_pk_fma_f32 v[160:161], v[160:161], v[116:117], v[120:121]
    v_pk_fma_f32 v[162:163], v[162:163], v[118:119], v[122:123]
    v_cvt_pk_bf16_f32 v160, v160, v161
    v_cvt_pk_bf16_f32 v161, v162, v163
    buffer_store_dwordx2 v[160:161], v12, s[48:51], s61 offen offset:16
k_done:
    s_endpgm
k_end:
.section .rodata,"a"
.p2align 6
.amdhsa_kernel adaLN_cond__ssm_conv_h3__dense_activation_squared_relu__prompt_kernel
  .amdhsa_next_free_vgpr 512
  .amdhsa_next_free_sgpr 102
  .amdhsa_accum_offset 256
  .amdhsa_group_segment_fixed_size 0
  .amdhsa_kernarg_size 128
  .amdhsa_user_sgpr_count 2
  .amdhsa_user_sgpr_kernarg_segment_ptr 1
  .amdhsa_system_sgpr_workgroup_id_x 1
.end_amdhsa_kernel
```
